```python
import torch

def _softmax(x, axis=-1):
    return torch.softmax(x, dim=axis)
def _gelu(x):
    return torch.nn.functional.gelu(x, approximate="tanh")
def _silu(x):
    return torch.nn.functional.silu(x)
def _sigmoid(x):
    return torch.sigmoid(x)
def _layernorm(x, axis=-1, eps=1e-5):
    m = x.mean(dim=axis, keepdim=True)
    v = x.var(dim=axis, keepdim=True, unbiased=False)
    return (x - m) / torch.sqrt(v + eps)
def _scatter_add(tgt, idx, src, axis=0):
    return tgt.clone().index_add_(axis, idx, src)
def _segment_sum(src, seg, n):
    out = torch.zeros((n,) + src.shape[1:], dtype=src.dtype)
    return out.index_add_(0, seg, src)
def _pad(x, pw):
    flat = tuple(v for pair in reversed(pw) for v in pair)
    return torch.nn.functional.pad(x, flat)

kernel_name = 'concat_heads__sliding_local_dilated__grouped_kv_mqa__prompt'

def setup_inputs():

    _w = (lambda a: (lambda t: t.to(torch.bfloat16) if t.is_floating_point() else t)(torch.as_tensor(a)))
    def _A_setup():
        B, S, D = 1, 2048, 512
        return {
            "x": _w((lambda *s: torch.randn(*s, dtype=torch.bfloat16) * 0.1)(B, S, D)),
            "wqkv": _w((lambda *s: torch.randn(*s, dtype=torch.bfloat16) * 0.8)(D, 3 * D)),
            "wo": _w((lambda *s: torch.randn(*s, dtype=torch.bfloat16) * 0.8)(D, D)),
        }
    _A_in = _A_setup()

    def _B_setup():
        B, S, D, H = 1, 2048, 512, 32
        Dh = D // H
        return {
            "x": _w((lambda *s: torch.randn(*s, dtype=torch.bfloat16) * 0.05)(B, S, D)),
            "wq": _w((lambda *s: torch.randn(*s, dtype=torch.bfloat16) * 3.2)(D, H * Dh)),
            "wk": _w((lambda *s: torch.randn(*s, dtype=torch.bfloat16) * 3.2)(D, Dh)),
            "wv": _w((lambda *s: torch.randn(*s, dtype=torch.bfloat16) * 1.6)(D, Dh)),
            "wo": _w((lambda *s: torch.randn(*s, dtype=torch.bfloat16) * 1.6)(H * Dh, D)),
        }
    _B_in = _B_setup()

    return {
        "A_x": _A_in["x"],
        "A_wqkv": _A_in["wqkv"],
        "A_wo": _A_in["wo"],
        "B_x": _B_in["x"],
        "B_wq": _B_in["wq"],
        "B_wk": _B_in["wk"],
        "B_wv": _B_in["wv"],
        "B_wo": _B_in["wo"],
    }

def reference(A_x, A_wqkv, A_wo, B_x, B_wq, B_wk, B_wv, B_wo):
    def _A_ref(x, wqkv, wo):
        B, S, D = x.shape
        H = 32; Dh = D // H
        W, dil = 8, 2
        qkv = (lambda x, *d: x.permute(*d))((x @ wqkv).reshape(B, S, 3, H, Dh), 2, 0, 3, 1, 4)
        q, k, v = qkv[0], qkv[1], qkv[2]
        scale = Dh ** -0.5
        pos = torch.arange(S)
        off = torch.arange(W) * dil
        idx = pos[:, None] - off[None, :]
        mask = idx >= 0
        idx_c = torch.where(mask, idx, 0).reshape(-1)
        kg = k[:, :, idx_c, :].reshape(B, H, S, W, Dh)
        vg = v[:, :, idx_c, :].reshape(B, H, S, W, Dh)
        logits = torch.einsum("bhsd,bhswd->bhsw", q, kg) * scale
        logits = torch.where(mask[None, None, :, :], logits, -1e9)
        attn = _softmax(logits, axis=-1)
        o = torch.einsum("bhsw,bhswd->bhsd", attn, vg)
        return (lambda x, *d: x.permute(*d))(o, 0, 2, 1, 3).reshape(B, S, D) @ wo

    def _B_ref(x, wq, wk, wv, wo):
        B, S, D = x.shape
        H = 32
        Dh = D // H
        q = (lambda x, *d: x.permute(*d))((x @ wq).reshape(B, S, H, Dh), 0, 2, 1, 3)
        k = x @ wk
        v = x @ wv
        scores = torch.einsum("bhqd,bkd->bhqk", q, k) * (Dh ** -0.5)
        p = _softmax(scores, axis=-1)
        o = torch.einsum("bhqk,bkd->bhqd", p, v)
        return (lambda x, *d: x.permute(*d))(o, 0, 2, 1, 3).reshape(B, S, H * Dh) @ wo

    a = _A_ref(A_x, A_wqkv, A_wo)
    b = _B_ref(B_x, B_wq, B_wk, B_wv, B_wo)
    return torch.concatenate([a, b], axis=-1)
```

```asm
; @launch grid=(256,1,1) block=(512,1,1) lds=163840
.amdgcn_target "amdgcn-amd-amdhsa--gfx950"
.text
.globl concat_heads__sliding_local_dilated__grouped_kv_mqa__prompt_kernel
.p2align 8
.type concat_heads__sliding_local_dilated__grouped_kv_mqa__prompt_kernel,@function
concat_heads__sliding_local_dilated__grouped_kv_mqa__prompt_kernel:
    s_load_dwordx2 s[20:21], s[0:1], 24
    s_load_dwordx2 s[28:29], s[0:1], 40
    s_load_dwordx2 s[46:47], s[0:1], 48
    s_load_dwordx2 s[24:25], s[0:1], 32
    s_load_dwordx2 s[44:45], s[0:1], 72
    s_load_dwordx2 s[40:41], s[0:1], 80
    s_load_dwordx2 s[8:9], s[0:1], 0
    s_load_dwordx2 s[12:13], s[0:1], 8
    s_load_dwordx2 s[16:17], s[0:1], 16
    s_load_dwordx2 s[32:33], s[0:1], 56
    s_load_dwordx2 s[36:37], s[0:1], 64
    s_memrealtime s[100:101]
    s_cmp_ge_u32 s2, 256
    s_cbranch_scc1 L_end
    v_lshrrev_b32 v8, 6, v0
    v_and_b32 v0, 63, v0
    v_readfirstlane_b32 s48, v8
    s_and_b32 s51, s2, 7
    s_bfe_u32 s4, s2, 0x20003
    s_lshl_b32 s49, s51, 2
    s_add_u32 s49, s49, s4
    s_lshr_b32 s50, s2, 5
    v_lshlrev_b32 v1, 4, v0
    v_lshrrev_b32 v15, 4, v0
    v_lshrrev_b32 v9, 3, v0
    v_and_b32 v10, 7, v0
    v_xor_b32 v11, v10, v15
    v_lshlrev_b32 v11, 4, v11
    v_lshl_add_u32 v12, v9, 10, v11
    v_xor_b32 v13, 64, v12
    v_add_u32 v13, 7168, v13
    v_mov_b32 v246, 0
    s_xor_b32 s48, s48, 7
    s_lshl_b32 s4, s4, 1
    s_lshl_b32 s73, s50, 7
    s_and_b32 s75, s48, 3
    s_add_u32 s4, s4, s50
    s_and_b32 s4, s4, 7
    s_mov_b32 s42, 0x800000
    s_mov_b32 s43, 0x20000
    s_cmp_lt_u32 s48, 4
    s_cbranch_scc1 L_X
    s_mov_b32 s22, 0x200000
    s_mov_b32 s23, 0x20000
    s_mov_b32 s30, 0x4000
    s_mov_b32 s31, 0x20000
    s_lshr_b32 s52, s50, 1
    s_add_u32 s52, s52, s48
    s_add_u32 s52, s52, 1
    s_and_b32 s52, s52, 3
    s_lshl_b32 s53, s52, 11
    s_lshl_b32 s54, s49, 2
    s_add_u32 s54, s54, s52
    s_lshl_b32 s54, s54, 14
    v_add_u32 v218, s54, v12
    v_add_u32 v219, s54, v13
    s_lshl_b32 s58, s4, 7
    s_cmp_lg_u32 s48, 7
    s_cbranch_scc1 L_Yset
    s_bitcmp1_b32 s50, 0
    s_waitcnt lgkmcnt(0)
    s_cselect_b32 s28, s46, s28
    s_cselect_b32 s29, s47, s29
    s_mov_b32 s51, s53
    s_mov_b32 s52, 131072
L_kvl:
    s_mov_b32 m0, s51
    s_and_b32 s58, s58, 1023
    buffer_load_dwordx4 v218, s[20:23], s58 offen nt lds
    buffer_load_dwordx4 v219, s[20:23], s58 offen offset:1024 nt lds
    s_mov_b32 m0, s52
    s_lshl_b32 s59, s58, 4
    buffer_load_dwordx4 v1, s[28:31], s59 offen lds
    buffer_load_dwordx4 v1, s[28:31], s59 offen offset:1024 lds
    s_add_u32 s58, s58, 128
    s_add_u32 s51, s51, 16384
    s_add_u32 s52, s52, 2048
    s_cmp_lt_u32 s52, 147456
    s_cbranch_scc1 L_kvl
    s_barrier
    s_branch L_Yset2
L_Yset:
    s_waitcnt lgkmcnt(0)
    s_getpc_b64 s[0:1]
L_pc:
    s_sub_u32 s0, s0, L_pc-concat_heads__sliding_local_dilated__grouped_kv_mqa__prompt_kernel
    s_subb_u32 s1, s1, 0
    s_lshr_b32 s51, s2, 3
    s_mul_i32 s51, s51, 3
    s_add_u32 s51, s51, s75
    s_lshl_b32 s51, s51, 8
    v_lshlrev_b32 v248, 7, v0
    v_add_u32 v248, s51, v248
    v_min_u32 v248, L_code_end-concat_heads__sliding_local_dilated__grouped_kv_mqa__prompt_kernel-4, v248
    s_mov_b64 exec, 3
    global_load_dword v249, v248, s[0:1]
    s_mov_b64 exec, -1
    s_barrier
    s_add_u32 m0, s53, 0
    s_and_b32 s58, s58, 1023
    buffer_load_dwordx4 v218, s[20:23], s58 offen nt lds
    buffer_load_dwordx4 v219, s[20:23], s58 offen offset:1024 nt lds
    s_add_u32 s58, s58, 128
    s_add_u32 m0, s53, 16384
    s_and_b32 s58, s58, 1023
    buffer_load_dwordx4 v218, s[20:23], s58 offen nt lds
    buffer_load_dwordx4 v219, s[20:23], s58 offen offset:1024 nt lds
    s_add_u32 s58, s58, 128
    s_add_u32 m0, s53, 32768
    s_and_b32 s58, s58, 1023
    buffer_load_dwordx4 v218, s[20:23], s58 offen nt lds
    buffer_load_dwordx4 v219, s[20:23], s58 offen offset:1024 nt lds
    s_add_u32 s58, s58, 128
    s_add_u32 m0, s53, 49152
    s_and_b32 s58, s58, 1023
    buffer_load_dwordx4 v218, s[20:23], s58 offen nt lds
    buffer_load_dwordx4 v219, s[20:23], s58 offen offset:1024 nt lds
    s_add_u32 s58, s58, 128
    s_add_u32 m0, s53, 65536
    s_and_b32 s58, s58, 1023
    buffer_load_dwordx4 v218, s[20:23], s58 offen nt lds
    buffer_load_dwordx4 v219, s[20:23], s58 offen offset:1024 nt lds
    s_add_u32 s58, s58, 128
    s_add_u32 m0, s53, 81920
    s_and_b32 s58, s58, 1023
    buffer_load_dwordx4 v218, s[20:23], s58 offen nt lds
    buffer_load_dwordx4 v219, s[20:23], s58 offen offset:1024 nt lds
    s_add_u32 s58, s58, 128
    s_add_u32 m0, s53, 98304
    s_and_b32 s58, s58, 1023
    buffer_load_dwordx4 v218, s[20:23], s58 offen nt lds
    buffer_load_dwordx4 v219, s[20:23], s58 offen offset:1024 nt lds
    s_add_u32 s58, s58, 128
    s_add_u32 m0, s53, 114688
    s_and_b32 s58, s58, 1023
    buffer_load_dwordx4 v218, s[20:23], s58 offen nt lds
    buffer_load_dwordx4 v219, s[20:23], s58 offen offset:1024 nt lds
L_Yset2:
    v_and_b32 v5, 31, v0
    v_lshrrev_b32 v6, 5, v0
    v_and_b32 v7, 15, v0
    v_lshrrev_b32 v235, 2, v7
    v_lshl_add_u32 v235, v6, 3, v235
    v_lshlrev_b32 v235, 7, v235
    v_and_b32 v248, 8, v7
    v_lshl_add_u32 v235, v248, 3, v235
    v_and_b32 v248, 16, v0
    v_lshl_add_u32 v235, v248, 1, v235
    v_and_b32 v248, 3, v0
    v_lshl_add_u32 v235, v248, 3, v235
    s_lshl_b32 s61, s75, 12
    s_add_u32 s3, s61, 131072
    v_add_u32 v238, s3, v1
    v_mov_b32 v236, 0xdddddddd
    s_mov_b32 s72, 0
    s_mov_b32 s38, 0x400000
    s_mov_b32 s39, 0x20000
    s_lshr_b32 s7, s48, 2
    s_lshl_b32 s6, s48, 14
    v_lshlrev_b32 v8, 9, v6
    v_sub_u32 v240, v235, v8
    v_add_u32 v240, s6, v240
    v_xor_b32 v241, 64, v240
    v_xor_b32 v8, v6, v7
    v_lshlrev_b32 v8, 4, v8
    v_lshl_add_u32 v8, v5, 8, v8
    v_add_u32 v242, s6, v8
    v_lshrrev_b32 v8, 3, v0
    s_lshl_b32 s6, s75, 3
    v_add_u32 v8, s6, v8
    v_and_b32 v9, 7, v0
    v_lshlrev_b32 v10, 1, v9
    v_and_b32 v11, 15, v8
    v_xor_b32 v10, v10, v11
    v_lshlrev_b32 v10, 4, v10
    v_lshl_add_u32 v10, v8, 8, v10
    s_lshl_b32 s6, s7, 16
    v_add_u32 v243, s6, v10
    v_lshlrev_b32 v9, 4, v9
    v_lshl_add_u32 v244, v8, 11, v9
    s_lshl_b32 s67, s49, 17
    s_lshl_b32 s6, s7, 10
    s_add_u32 s67, s67, s6
    s_add_u32 s67, s67, s73
    s_lshl_b32 s66, s49, 16
    s_add_u32 s6, s75, s49
    s_and_b32 s6, s6, 3
    s_lshl_b32 s6, s6, 13
    s_add_u32 s66, s66, s6
    s_lshl_b32 s6, s7, 21
    s_add_u32 s66, s66, s6
    s_add_u32 s66, s66, 0x100000
    v_bfe_u32 v14, v5, 1, 3
    v_xor_b32 v14, v14, v6
    v_lshlrev_b32 v14, 4, v14
    s_and_b32 s3, s48, 1
    s_lshl_b32 s3, s3, 12
    v_lshl_add_u32 v32, v5, 7, v14
    v_add_u32 v32, s3, v32
    v_xor_b32 v33, 32, v32
    v_xor_b32 v34, 64, v32
    v_xor_b32 v35, 96, v32
    s_and_b32 s7, s48, 2
    s_lshl_b32 s7, s7, 5
    v_xor_b32 v40, s7, v235
    v_add_u32 v40, 8192, v40
    v_add_u32 v41, 65536, v40
    s_mov_b32 s74, 0x3eb8aa3b
    v_add_u32 v36, 65536, v32
    v_add_u32 v37, 65536, v33
    v_add_u32 v38, 65536, v34
    v_add_u32 v39, 65536, v35
    s_mov_b32 s64, 0xffff
    s_mov_b32 s65, 0xffff
    s_and_b32 s51, s48, 1
    s_lshl_b32 s52, s49, 1
    s_add_u32 s51, s51, s52
    s_lshl_b32 s51, s51, 5
    s_lshl_b32 s52, s50, 2
    s_add_u32 s51, s51, s52
    s_and_b32 s52, s48, 2
    s_add_u32 s51, s51, s52
    s_lshl_b32 s51, s51, 10
    s_add_u32 s70, s51, 0x300000
    v_add_u32 v216, 147456, v1
    v_lshlrev_b32 v217, 4, v7
    v_lshl_add_u32 v217, v6, 8, v217
    v_add_u32 v217, 147456, v217
    v_and_b32 v9, 27, v0
    v_cmp_eq_u32 vcc, 16, v9
    v_mov_b32 v9, 0x53805380
    s_cmp_lg_u32 s48, 7
    v_cndmask_b32 v56, 0, v9, vcc
    s_cbranch_scc1 L_Yj
L_Y7:
    v_lshrrev_b32 v9, 1, v7
    v_xor_b32 v9, v9, v15
    v_lshlrev_b32 v9, 4, v9
    v_lshl_add_u32 v9, v7, 7, v9
    v_add_u32 v8, s53, v9
    v_xor_b32 v9, 64, v8
    v_add_u32 v10, 65536, v8
    v_add_u32 v11, 65536, v9
    v_lshlrev_b32 v248, 8, v15
    v_lshl_add_u32 v248, v7, 3, v248
    v_add_u32 v248, 131072, v248
    v_and_b32 v249, 1, v15
    v_lshrrev_b32 v250, 1, v15
    s_lshr_b32 s51, s50, 2
    s_lshl_b32 s55, s49, 1
    s_add_u32 s51, s51, s55
    s_lshl_b32 s51, s51, 11
    s_bfe_u32 s55, s50, 0x10001
    s_lshl_b32 s52, s49, 3
    s_add_u32 s52, s52, s50
    s_lshl_b32 s71, s52, 3
    s_add_u32 s71, s71, 0x44000
    s_lshl_b32 s52, s52, 6
    s_add_u32 s5, s52, 0x40000
    s_waitcnt vmcnt(28)
    ds_read_b128 v[96:99], v8 offset:0
    ds_read_b64_tr_b16 v[100:101], v248 offset:0
    ds_read_b64_tr_b16 v[102:103], v248 offset:128
    ds_read_b128 v[104:107], v9 offset:0
    ds_read_b64_tr_b16 v[108:109], v248 offset:1024
    ds_read_b64_tr_b16 v[110:111], v248 offset:1152
    s_waitcnt vmcnt(24)
    ds_read_b128 v[112:115], v8 offset:16384
    ds_read_b64_tr_b16 v[116:117], v248 offset:2048
    ds_read_b64_tr_b16 v[118:119], v248 offset:2176
    ds_read_b128 v[120:123], v9 offset:16384
    ds_read_b64_tr_b16 v[124:125], v248 offset:3072
    ds_read_b64_tr_b16 v[126:127], v248 offset:3200
    s_waitcnt vmcnt(20)
    ds_read_b128 v[128:131], v8 offset:32768
    ds_read_b64_tr_b16 v[132:133], v248 offset:4096
    ds_read_b64_tr_b16 v[134:135], v248 offset:4224
    ds_read_b128 v[136:139], v9 offset:32768
    ds_read_b64_tr_b16 v[140:141], v248 offset:5120
    ds_read_b64_tr_b16 v[142:143], v248 offset:5248
    s_waitcnt vmcnt(16)
    ds_read_b128 v[144:147], v8 offset:49152
    ds_read_b64_tr_b16 v[148:149], v248 offset:6144
    ds_read_b64_tr_b16 v[150:151], v248 offset:6272
    ds_read_b128 v[152:155], v9 offset:49152
    ds_read_b64_tr_b16 v[156:157], v248 offset:7168
    ds_read_b64_tr_b16 v[158:159], v248 offset:7296
    s_waitcnt vmcnt(12)
    ds_read_b128 v[160:163], v10 offset:0
    ds_read_b64_tr_b16 v[164:165], v248 offset:8192
    ds_read_b64_tr_b16 v[166:167], v248 offset:8320
    ds_read_b128 v[168:171], v11 offset:0
    ds_read_b64_tr_b16 v[172:173], v248 offset:9216
    ds_read_b64_tr_b16 v[174:175], v248 offset:9344
    s_waitcnt vmcnt(8)
    ds_read_b128 v[176:179], v10 offset:16384
    ds_read_b64_tr_b16 v[180:181], v248 offset:10240
    ds_read_b64_tr_b16 v[182:183], v248 offset:10368
    ds_read_b128 v[184:187], v11 offset:16384
    ds_read_b64_tr_b16 v[188:189], v248 offset:11264
    ds_read_b64_tr_b16 v[190:191], v248 offset:11392
    s_waitcnt vmcnt(4)
    ds_read_b128 v[192:195], v10 offset:32768
    ds_read_b64_tr_b16 v[196:197], v248 offset:12288
    ds_read_b64_tr_b16 v[198:199], v248 offset:12416
    ds_read_b128 v[200:203], v11 offset:32768
    ds_read_b64_tr_b16 v[204:205], v248 offset:13312
    ds_read_b64_tr_b16 v[206:207], v248 offset:13440
    s_waitcnt vmcnt(0)
    ds_read_b128 v[208:211], v10 offset:49152
    ds_read_b64_tr_b16 v[212:213], v248 offset:14336
    ds_read_b64_tr_b16 v[214:215], v248 offset:14464
    ds_read_b128 v[24:27], v11 offset:49152
    ds_read_b64_tr_b16 v[28:29], v248 offset:15360
    ds_read_b64_tr_b16 v[30:31], v248 offset:15488
    global_load_dwordx2 v[90:91], v246, s[44:45] sc1
    s_bitcmp1_b32 s50, 0
    s_cselect_b32 s59, 0x53800000, 1.0
    s_cbranch_scc1 L_kv_v
    v_lshlrev_b32 v249, 9, v249
    v_lshl_add_u32 v249, v250, 3, v249
    s_lshl_b32 s55, s55, 8
    s_waitcnt lgkmcnt(12)
    v_mfma_f32_16x16x32_bf16 v[16:19], v[100:103], v[96:99], 0
    v_mfma_f32_16x16x32_bf16 v[20:23], v[108:111], v[104:107], 0
    v_mfma_f32_16x16x32_bf16 v[16:19], v[116:119], v[112:115], v[16:19]
    v_mfma_f32_16x16x32_bf16 v[20:23], v[124:127], v[120:123], v[20:23]
    v_mfma_f32_16x16x32_bf16 v[16:19], v[132:135], v[128:131], v[16:19]
    v_mfma_f32_16x16x32_bf16 v[20:23], v[140:143], v[136:139], v[20:23]
    v_mfma_f32_16x16x32_bf16 v[16:19], v[148:151], v[144:147], v[16:19]
    v_mfma_f32_16x16x32_bf16 v[20:23], v[156:159], v[152:155], v[20:23]
    v_mfma_f32_16x16x32_bf16 v[16:19], v[164:167], v[160:163], v[16:19]
    v_mfma_f32_16x16x32_bf16 v[20:23], v[172:175], v[168:171], v[20:23]
    v_mfma_f32_16x16x32_bf16 v[16:19], v[180:183], v[176:179], v[16:19]
    v_mfma_f32_16x16x32_bf16 v[20:23], v[188:191], v[184:187], v[20:23]
    s_waitcnt lgkmcnt(0)
    v_mfma_f32_16x16x32_bf16 v[16:19], v[196:199], v[192:195], v[16:19]
    v_mfma_f32_16x16x32_bf16 v[20:23], v[204:207], v[200:203], v[20:23]
    v_mfma_f32_16x16x32_bf16 v[16:19], v[212:215], v[208:211], v[16:19]
    v_mfma_f32_16x16x32_bf16 v[20:23], v[28:31], v[24:27], v[20:23]
    s_branch L_kv_j
L_kv_v:
    v_lshlrev_b32 v249, 3, v249
    v_lshl_add_u32 v249, v250, 8, v249
    s_lshl_b32 s55, s55, 9
    s_add_u32 s55, s55, 1024
    s_waitcnt lgkmcnt(12)
    v_mfma_f32_16x16x32_bf16 v[16:19], v[96:99], v[100:103], 0
    v_mfma_f32_16x16x32_bf16 v[20:23], v[104:107], v[108:111], 0
    v_mfma_f32_16x16x32_bf16 v[16:19], v[112:115], v[116:119], v[16:19]
    v_mfma_f32_16x16x32_bf16 v[20:23], v[120:123], v[124:127], v[20:23]
    v_mfma_f32_16x16x32_bf16 v[16:19], v[128:131], v[132:135], v[16:19]
    v_mfma_f32_16x16x32_bf16 v[20:23], v[136:139], v[140:143], v[20:23]
    v_mfma_f32_16x16x32_bf16 v[16:19], v[144:147], v[148:151], v[16:19]
    v_mfma_f32_16x16x32_bf16 v[20:23], v[152:155], v[156:159], v[20:23]
    v_mfma_f32_16x16x32_bf16 v[16:19], v[160:163], v[164:167], v[16:19]
    v_mfma_f32_16x16x32_bf16 v[20:23], v[168:171], v[172:175], v[20:23]
    v_mfma_f32_16x16x32_bf16 v[16:19], v[176:179], v[180:183], v[16:19]
    v_mfma_f32_16x16x32_bf16 v[20:23], v[184:187], v[188:191], v[20:23]
    s_waitcnt lgkmcnt(0)
    v_mfma_f32_16x16x32_bf16 v[16:19], v[192:195], v[196:199], v[16:19]
    v_mfma_f32_16x16x32_bf16 v[20:23], v[200:203], v[204:207], v[20:23]
    v_mfma_f32_16x16x32_bf16 v[16:19], v[208:211], v[212:215], v[16:19]
    v_mfma_f32_16x16x32_bf16 v[20:23], v[24:27], v[28:31], v[20:23]
L_kv_j:
    v_lshl_add_u32 v249, v7, 4, v249
    s_add_u32 s51, s51, s55
    s_nop 5
    v_pk_add_f32 v[16:17], v[16:17], v[20:21]
    v_pk_add_f32 v[18:19], v[18:19], v[22:23]
    v_mul_f32 v16, s59, v16
    v_mul_f32 v17, s59, v17
    v_mul_f32 v18, s59, v18
    v_mul_f32 v19, s59, v19
    v_cvt_pk_bf16_f32 v250, v16, v17
    v_cvt_pk_bf16_f32 v251, v18, v19
    buffer_store_dwordx2 v[250:251], v249, s[40:43], s51 offen sc1
L_Yj:
    v_mov_b32 v57, v56
    v_mov_b32 v58, v56
    v_mov_b32 v59, v56
    v_mov_b32 v60, v56
    v_mov_b32 v61, v56
    v_mov_b32 v62, v56
    v_mov_b32 v63, v56
    v_mov_b32 v64, v56
    v_mov_b32 v65, v56
    v_mov_b32 v66, v56
    v_mov_b32 v67, v56
    v_mov_b32 v68, v56
    v_mov_b32 v69, v56
    v_mov_b32 v70, v56
    v_mov_b32 v71, v56
    v_mov_b32 v72, v56
    v_mov_b32 v73, v56
    v_mov_b32 v74, v56
    v_mov_b32 v75, v56
    v_mov_b32 v76, v56
    v_mov_b32 v77, v56
    v_mov_b32 v78, v56
    v_mov_b32 v79, v56
    v_mov_b32 v80, v56
    v_mov_b32 v81, v56
    v_mov_b32 v82, v56
    v_mov_b32 v83, v56
    v_mov_b32 v84, v56
    v_mov_b32 v85, v56
    v_mov_b32 v86, v56
    v_mov_b32 v87, v56
    v_mov_b32 v160, 0
    v_mov_b32 v161, 0
    v_mov_b32 v162, 0
    v_mov_b32 v163, 0
    v_mov_b32 v164, 0
    v_mov_b32 v165, 0
    v_mov_b32 v166, 0
    v_mov_b32 v167, 0
    v_mov_b32 v168, 0
    v_mov_b32 v169, 0
    v_mov_b32 v170, 0
    v_mov_b32 v171, 0
    v_mov_b32 v172, 0
    v_mov_b32 v173, 0
    v_mov_b32 v174, 0
    v_mov_b32 v175, 0
    v_mov_b32 v176, 0
    v_mov_b32 v177, 0
    v_mov_b32 v178, 0
    v_mov_b32 v179, 0
    v_mov_b32 v180, 0
    v_mov_b32 v181, 0
    v_mov_b32 v182, 0
    v_mov_b32 v183, 0
    v_mov_b32 v184, 0
    v_mov_b32 v185, 0
    v_mov_b32 v186, 0
    v_mov_b32 v187, 0
    v_mov_b32 v188, 0
    v_mov_b32 v189, 0
    v_mov_b32 v190, 0
    v_mov_b32 v191, 0
    s_waitcnt vmcnt(0)
    s_cmp_lg_u32 s48, 7
    s_cbranch_scc1 L_flag_done
    s_mov_b32 s69, 200000
    s_waitcnt vmcnt(0)
L_fw_kv:
    v_cmp_eq_u32 vcc, 0, v90
    s_cbranch_vccz L_fs_kv
    global_load_dwordx2 v[90:91], v246, s[44:45] sc1
    s_waitcnt vmcnt(0)
    s_sub_u32 s69, s69, 1
    s_cbranch_scc0 L_fw_kv
L_fs_kv:
    s_mov_b64 exec, 1
    buffer_store_dwordx2 v[90:91], v246, s[40:43], s5 offen sc1
    s_mov_b64 exec, -1
L_flag_done:
    s_barrier
    ds_read_b128 v[96:99], v32 offset:0
    ds_read_b64_tr_b16 v[100:101], v40 offset:0
    ds_read_b64_tr_b16 v[102:103], v40 offset:512
    ds_read_b128 v[104:107], v33 offset:0
    ds_read_b64_tr_b16 v[108:109], v40 offset:2048
    ds_read_b64_tr_b16 v[110:111], v40 offset:2560
    ds_read_b128 v[112:115], v34 offset:0
    ds_read_b64_tr_b16 v[116:117], v40 offset:4096
    ds_read_b64_tr_b16 v[118:119], v40 offset:4608
    ds_read_b128 v[120:123], v35 offset:0
    ds_read_b64_tr_b16 v[124:125], v40 offset:6144
    ds_read_b64_tr_b16 v[126:127], v40 offset:6656
    ds_read_b128 v[128:131], v32 offset:16384
    ds_read_b64_tr_b16 v[132:133], v40 offset:16384
    ds_read_b64_tr_b16 v[134:135], v40 offset:16896
    s_waitcnt lgkmcnt(12)
    v_mfma_f32_32x32x16_bf16 v[16:31], v[100:103], v[96:99], 0
    ds_read_b128 v[136:139], v33 offset:16384
    ds_read_b64_tr_b16 v[140:141], v40 offset:18432
    ds_read_b64_tr_b16 v[142:143], v40 offset:18944
    s_waitcnt lgkmcnt(12)
    v_mfma_f32_32x32x16_bf16 v[16:31], v[108:111], v[104:107], v[16:31]
    ds_read_b128 v[144:147], v34 offset:16384
    ds_read_b64_tr_b16 v[148:149], v40 offset:20480
    ds_read_b64_tr_b16 v[150:151], v40 offset:20992
    s_waitcnt lgkmcnt(12)
    v_mfma_f32_32x32x16_bf16 v[16:31], v[116:119], v[112:115], v[16:31]
    ds_read_b128 v[152:155], v35 offset:16384
    ds_read_b64_tr_b16 v[156:157], v40 offset:22528
    ds_read_b64_tr_b16 v[158:159], v40 offset:23040
    s_waitcnt lgkmcnt(12)
    v_mfma_f32_32x32x16_bf16 v[16:31], v[124:127], v[120:123], v[16:31]
    ds_read_b128 v[96:99], v32 offset:32768
    ds_read_b64_tr_b16 v[100:101], v40 offset:32768
    ds_read_b64_tr_b16 v[102:103], v40 offset:33280
    s_waitcnt lgkmcnt(12)
    v_mfma_f32_32x32x16_bf16 v[16:31], v[132:135], v[128:131], v[16:31]
    ds_read_b128 v[104:107], v33 offset:32768
    ds_read_b64_tr_b16 v[108:109], v40 offset:34816
    ds_read_b64_tr_b16 v[110:111], v40 offset:35328
    s_waitcnt lgkmcnt(12)
    v_mfma_f32_32x32x16_bf16 v[16:31], v[140:143], v[136:139], v[16:31]
    ds_read_b128 v[112:115], v34 offset:32768
    ds_read_b64_tr_b16 v[116:117], v40 offset:36864
    ds_read_b64_tr_b16 v[118:119], v40 offset:37376
    s_waitcnt lgkmcnt(12)
    v_mfma_f32_32x32x16_bf16 v[16:31], v[148:151], v[144:147], v[16:31]
    ds_read_b128 v[120:123], v35 offset:32768
    ds_read_b64_tr_b16 v[124:125], v40 offset:38912
    ds_read_b64_tr_b16 v[126:127], v40 offset:39424
    s_waitcnt lgkmcnt(12)
    v_mfma_f32_32x32x16_bf16 v[16:31], v[156:159], v[152:155], v[16:31]
    ds_read_b128 v[128:131], v32 offset:49152
    ds_read_b64_tr_b16 v[132:133], v40 offset:49152
    ds_read_b64_tr_b16 v[134:135], v40 offset:49664
    s_barrier
    s_waitcnt lgkmcnt(12)
    v_mfma_f32_32x32x16_bf16 v[16:31], v[100:103], v[96:99], v[16:31]
    ds_read_b128 v[136:139], v33 offset:49152
    ds_read_b64_tr_b16 v[140:141], v40 offset:51200
    ds_read_b64_tr_b16 v[142:143], v40 offset:51712
    s_waitcnt lgkmcnt(12)
    v_mfma_f32_32x32x16_bf16 v[16:31], v[108:111], v[104:107], v[16:31]
    ds_read_b128 v[144:147], v34 offset:49152
    ds_read_b64_tr_b16 v[148:149], v40 offset:53248
    ds_read_b64_tr_b16 v[150:151], v40 offset:53760
    s_waitcnt lgkmcnt(12)
    v_mfma_f32_32x32x16_bf16 v[16:31], v[116:119], v[112:115], v[16:31]
    ds_read_b128 v[152:155], v35 offset:49152
    ds_read_b64_tr_b16 v[156:157], v40 offset:55296
    ds_read_b64_tr_b16 v[158:159], v40 offset:55808
    s_waitcnt lgkmcnt(12)
    v_mfma_f32_32x32x16_bf16 v[16:31], v[124:127], v[120:123], v[16:31]
    ds_read_b128 v[96:99], v36 offset:0
    ds_read_b64_tr_b16 v[100:101], v41 offset:0
    ds_read_b64_tr_b16 v[102:103], v41 offset:512
    s_waitcnt lgkmcnt(12)
    v_mfma_f32_32x32x16_bf16 v[16:31], v[132:135], v[128:131], v[16:31]
    ds_read_b128 v[104:107], v37 offset:0
    ds_read_b64_tr_b16 v[108:109], v41 offset:2048
    ds_read_b64_tr_b16 v[110:111], v41 offset:2560
    s_waitcnt lgkmcnt(12)
    v_mfma_f32_32x32x16_bf16 v[16:31], v[140:143], v[136:139], v[16:31]
    ds_read_b128 v[112:115], v38 offset:0
    ds_read_b64_tr_b16 v[116:117], v41 offset:4096
    ds_read_b64_tr_b16 v[118:119], v41 offset:4608
    s_waitcnt lgkmcnt(12)
    v_mfma_f32_32x32x16_bf16 v[16:31], v[148:151], v[144:147], v[16:31]
    ds_read_b128 v[120:123], v39 offset:0
    ds_read_b64_tr_b16 v[124:125], v41 offset:6144
    ds_read_b64_tr_b16 v[126:127], v41 offset:6656
    s_waitcnt lgkmcnt(12)
    v_mfma_f32_32x32x16_bf16 v[16:31], v[156:159], v[152:155], v[16:31]
    ds_read_b128 v[128:131], v36 offset:16384
    ds_read_b64_tr_b16 v[132:133], v41 offset:16384
    ds_read_b64_tr_b16 v[134:135], v41 offset:16896
    s_waitcnt lgkmcnt(12)
    v_mfma_f32_32x32x16_bf16 v[16:31], v[100:103], v[96:99], v[16:31]
    ds_read_b128 v[136:139], v37 offset:16384
    ds_read_b64_tr_b16 v[140:141], v41 offset:18432
    ds_read_b64_tr_b16 v[142:143], v41 offset:18944
    s_waitcnt lgkmcnt(12)
    v_mfma_f32_32x32x16_bf16 v[16:31], v[108:111], v[104:107], v[16:31]
    ds_read_b128 v[144:147], v38 offset:16384
    ds_read_b64_tr_b16 v[148:149], v41 offset:20480
    ds_read_b64_tr_b16 v[150:151], v41 offset:20992
    s_waitcnt lgkmcnt(12)
    v_mfma_f32_32x32x16_bf16 v[16:31], v[116:119], v[112:115], v[16:31]
    ds_read_b128 v[152:155], v39 offset:16384
    ds_read_b64_tr_b16 v[156:157], v41 offset:22528
    ds_read_b64_tr_b16 v[158:159], v41 offset:23040
    s_waitcnt lgkmcnt(12)
    v_mfma_f32_32x32x16_bf16 v[16:31], v[124:127], v[120:123], v[16:31]
    ds_read_b128 v[96:99], v36 offset:32768
    ds_read_b64_tr_b16 v[100:101], v41 offset:32768
    ds_read_b64_tr_b16 v[102:103], v41 offset:33280
    s_waitcnt lgkmcnt(12)
    v_mfma_f32_32x32x16_bf16 v[16:31], v[132:135], v[128:131], v[16:31]
    ds_read_b128 v[104:107], v37 offset:32768
    ds_read_b64_tr_b16 v[108:109], v41 offset:34816
    ds_read_b64_tr_b16 v[110:111], v41 offset:35328
    s_waitcnt lgkmcnt(12)
    v_mfma_f32_32x32x16_bf16 v[16:31], v[140:143], v[136:139], v[16:31]
    ds_read_b128 v[112:115], v38 offset:32768
    ds_read_b64_tr_b16 v[116:117], v41 offset:36864
    ds_read_b64_tr_b16 v[118:119], v41 offset:37376
    s_waitcnt lgkmcnt(12)
    v_mfma_f32_32x32x16_bf16 v[16:31], v[148:151], v[144:147], v[16:31]
    ds_read_b128 v[120:123], v39 offset:32768
    ds_read_b64_tr_b16 v[124:125], v41 offset:38912
    ds_read_b64_tr_b16 v[126:127], v41 offset:39424
    s_waitcnt lgkmcnt(12)
    v_mfma_f32_32x32x16_bf16 v[16:31], v[156:159], v[152:155], v[16:31]
    ds_read_b128 v[128:131], v36 offset:49152
    ds_read_b64_tr_b16 v[132:133], v41 offset:49152
    ds_read_b64_tr_b16 v[134:135], v41 offset:49664
    s_waitcnt lgkmcnt(12)
    v_mfma_f32_32x32x16_bf16 v[16:31], v[100:103], v[96:99], v[16:31]
    ds_read_b128 v[136:139], v37 offset:49152
    ds_read_b64_tr_b16 v[140:141], v41 offset:51200
    ds_read_b64_tr_b16 v[142:143], v41 offset:51712
    s_waitcnt lgkmcnt(12)
    v_mfma_f32_32x32x16_bf16 v[16:31], v[108:111], v[104:107], v[16:31]
    ds_read_b128 v[144:147], v38 offset:49152
    ds_read_b64_tr_b16 v[148:149], v41 offset:53248
    ds_read_b64_tr_b16 v[150:151], v41 offset:53760
    s_waitcnt lgkmcnt(12)
    v_mfma_f32_32x32x16_bf16 v[16:31], v[116:119], v[112:115], v[16:31]
    ds_read_b128 v[152:155], v39 offset:49152
    ds_read_b64_tr_b16 v[156:157], v41 offset:55296
    ds_read_b64_tr_b16 v[158:159], v41 offset:55808
    s_waitcnt lgkmcnt(12)
    v_mfma_f32_32x32x16_bf16 v[16:31], v[124:127], v[120:123], v[16:31]
    s_waitcnt lgkmcnt(9)
    v_mfma_f32_32x32x16_bf16 v[16:31], v[132:135], v[128:131], v[16:31]
    s_waitcnt lgkmcnt(6)
    v_mfma_f32_32x32x16_bf16 v[16:31], v[140:143], v[136:139], v[16:31]
    s_waitcnt lgkmcnt(3)
    v_mfma_f32_32x32x16_bf16 v[16:31], v[148:151], v[144:147], v[16:31]
    s_waitcnt lgkmcnt(0)
    v_mfma_f32_32x32x16_bf16 v[16:31], v[156:159], v[152:155], v[16:31]
    s_mov_b32 s55, 0
    s_setprio 1
    s_cmp_lg_u32 s48, 7
    s_cbranch_scc1 L_nodense
    s_mov_b64 exec, 1
    buffer_store_dwordx2 v[90:91], v246, s[40:43], s71 offen sc1
    s_mov_b64 exec, -1
L_nodense:
    s_nop 7
    v_pk_mul_f32 v[16:17], v[16:17], s[74:75] op_sel_hi:[1,0]
    v_pk_mul_f32 v[18:19], v[18:19], s[74:75] op_sel_hi:[1,0]
    v_pk_mul_f32 v[20:21], v[20:21], s[74:75] op_sel_hi:[1,0]
    v_pk_mul_f32 v[22:23], v[22:23], s[74:75] op_sel_hi:[1,0]
    v_pk_mul_f32 v[24:25], v[24:25], s[74:75] op_sel_hi:[1,0]
    v_pk_mul_f32 v[26:27], v[26:27], s[74:75] op_sel_hi:[1,0]
    v_pk_mul_f32 v[28:29], v[28:29], s[74:75] op_sel_hi:[1,0]
    v_pk_mul_f32 v[30:31], v[30:31], s[74:75] op_sel_hi:[1,0]
    v_cvt_pk_bf16_f32 v208, v16, v17
    v_cvt_pk_bf16_f32 v209, v18, v19
    v_cvt_pk_bf16_f32 v210, v20, v21
    v_cvt_pk_bf16_f32 v211, v22, v23
    v_cvt_pk_bf16_f32 v212, v24, v25
    v_cvt_pk_bf16_f32 v213, v26, v27
    v_cvt_pk_bf16_f32 v214, v28, v29
    v_cvt_pk_bf16_f32 v215, v30, v31
    s_barrier
    ds_read_b128 v[192:195], v216
    ds_read_b128 v[196:199], v216 offset:2048
    s_mov_b64 exec, s[64:65]
    ds_read_b128 v[56:59], v217 offset:1024
    ds_read_b128 v[60:63], v217 offset:1536
    ds_read_b128 v[64:67], v217 offset:3072
    ds_read_b128 v[68:71], v217 offset:3584
    s_mov_b64 exec, -1
    s_waitcnt lgkmcnt(5)
    v_mfma_f32_32x32x16_bf16 v[96:111], v[192:195], v[208:211], 0
    v_mfma_f32_32x32x16_bf16 v[112:127], v[192:195], v[212:215], 0
    s_nop 10
    v_max3_f32 v8, v96, v97, v98
    v_max3_f32 v9, v99, v100, v101
    v_max3_f32 v8, v8, v102, v103
    v_max3_f32 v9, v9, v104, v105
    v_max3_f32 v8, v8, v106, v107
    v_max3_f32 v9, v9, v108, v109
    v_max3_f32 v8, v8, v110, v111
    v_max_f32 v8, v8, v9
    v_mov_b32 v9, v8
    s_nop 1
    v_permlane32_swap_b32 v8, v9
    v_max_f32 v8, v8, v9
    v_sub_f32 v8, 0xc2c80000, v8
    v_pk_mov_b32 v[128:129], v[8:9], v[8:9] op_sel:[0,0]
    v_pk_mov_b32 v[130:131], v[8:9], v[8:9] op_sel:[0,0]
    v_pk_mov_b32 v[132:133], v[8:9], v[8:9] op_sel:[0,0]
    v_pk_mov_b32 v[134:135], v[8:9], v[8:9] op_sel:[0,0]
    v_pk_mov_b32 v[136:137], v[8:9], v[8:9] op_sel:[0,0]
    v_pk_mov_b32 v[138:139], v[8:9], v[8:9] op_sel:[0,0]
    v_pk_mov_b32 v[140:141], v[8:9], v[8:9] op_sel:[0,0]
    v_pk_mov_b32 v[142:143], v[8:9], v[8:9] op_sel:[0,0]
    v_max3_f32 v10, v112, v113, v114
    v_max3_f32 v11, v115, v116, v117
    v_mfma_f32_32x32x16_bf16 v[96:111], v[192:195], v[208:211], v[128:143]
    v_max3_f32 v11, v11, v118, v119
    v_max3_f32 v10, v10, v120, v121
    v_max3_f32 v11, v11, v122, v123
    v_max3_f32 v10, v10, v124, v125
    v_max3_f32 v11, v11, v126, v127
    v_max_f32 v10, v10, v11
    v_mov_b32 v11, v10
    s_nop 1
    v_permlane32_swap_b32 v10, v11
    v_max_f32 v10, v10, v11
    v_sub_f32 v10, 0xc2c80000, v10
    v_pk_mov_b32 v[144:145], v[10:11], v[10:11] op_sel:[0,0]
    v_pk_mov_b32 v[146:147], v[10:11], v[10:11] op_sel:[0,0]
    v_pk_mov_b32 v[148:149], v[10:11], v[10:11] op_sel:[0,0]
    v_pk_mov_b32 v[150:151], v[10:11], v[10:11] op_sel:[0,0]
    v_pk_mov_b32 v[152:153], v[10:11], v[10:11] op_sel:[0,0]
    v_pk_mov_b32 v[154:155], v[10:11], v[10:11] op_sel:[0,0]
    v_pk_mov_b32 v[156:157], v[10:11], v[10:11] op_sel:[0,0]
    v_pk_mov_b32 v[158:159], v[10:11], v[10:11] op_sel:[0,0]
    s_waitcnt lgkmcnt(0)
    v_exp_f32 v96, v96
    v_exp_f32 v97, v97
    s_branch L_att_entry
    .p2align 6
L_att_top:
    v_xor_b32 v216, 16384, v216
    v_xor_b32 v217, 16384, v217
    s_cmp_eq_u32 s55, 8
    s_barrier
    v_exp_f32 v96, v96
    v_exp_f32 v97, v97
    v_smfmac_f32_32x32x32_bf16 v[176:191], v[68:71], v[120:127], v236
    s_mov_b64 exec, s[64:65]
    ds_read_b128 v[56:59], v217 offset:1024
    ds_read_b128 v[60:63], v217 offset:1536
    ds_read_b128 v[64:67], v217 offset:3072
    ds_read_b128 v[68:71], v217 offset:3584
    s_mov_b64 exec, -1
    v_exp_f32 v98, v98
    v_exp_f32 v99, v99
    v_exp_f32 v100, v100
    v_mfma_f32_32x32x16_bf16 v[112:127], v[200:203], v[212:215], v[144:159]
    ds_read_b128 v[192:195], v216 offset:0
    ds_read_b128 v[196:199], v216 offset:2048
    v_exp_f32 v101, v101
    v_exp_f32 v102, v102
    v_exp_f32 v103, v103
    v_exp_f32 v104, v104
    v_exp_f32 v105, v105
    v_smfmac_f32_32x32x32_bf16 v[160:175], v[72:75], v[96:103], v236
    v_exp_f32 v106, v106
    v_exp_f32 v107, v107
    v_exp_f32 v108, v108
    v_exp_f32 v109, v109
    v_exp_f32 v110, v110
    v_exp_f32 v111, v111
    v_exp_f32 v112, v112
    v_exp_f32 v113, v113
    v_smfmac_f32_32x32x32_bf16 v[160:175], v[76:79], v[104:111], v236
    v_exp_f32 v114, v114
    v_exp_f32 v115, v115
    v_exp_f32 v116, v116
    v_mfma_f32_32x32x16_bf16 v[96:111], v[204:207], v[208:211], v[128:143]
    v_exp_f32 v117, v117
    v_exp_f32 v118, v118
    v_exp_f32 v119, v119
    v_exp_f32 v120, v120
    v_exp_f32 v121, v121
    v_smfmac_f32_32x32x32_bf16 v[176:191], v[72:75], v[112:119], v236
    v_exp_f32 v122, v122
    v_exp_f32 v123, v123
    v_exp_f32 v124, v124
    v_exp_f32 v125, v125
    v_exp_f32 v126, v126
    v_exp_f32 v127, v127
    v_exp_f32 v96, v96
    v_exp_f32 v97, v97
    v_smfmac_f32_32x32x32_bf16 v[176:191], v[76:79], v[120:127], v236
    v_exp_f32 v98, v98
    v_exp_f32 v99, v99
    v_exp_f32 v100, v100
    v_mfma_f32_32x32x16_bf16 v[112:127], v[204:207], v[212:215], v[144:159]
    v_exp_f32 v101, v101
    v_exp_f32 v102, v102
    v_exp_f32 v103, v103
    v_exp_f32 v104, v104
    v_exp_f32 v105, v105
    v_smfmac_f32_32x32x32_bf16 v[160:175], v[80:83], v[96:103], v236
    v_exp_f32 v106, v106
    v_exp_f32 v107, v107
    v_exp_f32 v108, v108
    v_exp_f32 v109, v109
    v_exp_f32 v110, v110
    v_exp_f32 v111, v111
    v_exp_f32 v112, v112
    v_exp_f32 v113, v113
    v_smfmac_f32_32x32x32_bf16 v[160:175], v[84:87], v[104:111], v236
    s_waitcnt lgkmcnt(0)
    v_exp_f32 v114, v114
    v_exp_f32 v115, v115
    v_exp_f32 v116, v116
    v_mfma_f32_32x32x16_bf16 v[96:111], v[192:195], v[208:211], v[128:143]
    v_exp_f32 v117, v117
    v_exp_f32 v118, v118
    v_exp_f32 v119, v119
    v_exp_f32 v120, v120
    v_exp_f32 v121, v121
    v_smfmac_f32_32x32x32_bf16 v[176:191], v[80:83], v[112:119], v236
    v_exp_f32 v122, v122
    v_exp_f32 v123, v123
    v_exp_f32 v124, v124
    v_exp_f32 v125, v125
    v_exp_f32 v126, v126
    v_exp_f32 v127, v127
    s_cbranch_scc1 L_att_done
    v_exp_f32 v96, v96
    v_exp_f32 v97, v97
    v_smfmac_f32_32x32x32_bf16 v[176:191], v[84:87], v[120:127], v236
L_att_entry:
    s_mov_b64 exec, s[64:65]
    ds_read_b128 v[72:75], v217 offset:5120
    ds_read_b128 v[76:79], v217 offset:5632
    ds_read_b128 v[80:83], v217 offset:7168
    ds_read_b128 v[84:87], v217 offset:7680
    s_mov_b64 exec, -1
    v_exp_f32 v98, v98
    v_exp_f32 v99, v99
    v_exp_f32 v100, v100
    v_mfma_f32_32x32x16_bf16 v[112:127], v[192:195], v[212:215], v[144:159]
    ds_read_b128 v[200:203], v216 offset:4096
    ds_read_b128 v[204:207], v216 offset:6144
    v_exp_f32 v101, v101
    v_exp_f32 v102, v102
    v_exp_f32 v103, v103
    v_exp_f32 v104, v104
    v_exp_f32 v105, v105
    v_smfmac_f32_32x32x32_bf16 v[160:175], v[56:59], v[96:103], v236
    v_exp_f32 v106, v106
    v_exp_f32 v107, v107
    v_exp_f32 v108, v108
    v_exp_f32 v109, v109
    v_exp_f32 v110, v110
    v_exp_f32 v111, v111
    v_exp_f32 v112, v112
    v_exp_f32 v113, v113
    v_smfmac_f32_32x32x32_bf16 v[160:175], v[60:63], v[104:111], v236
    v_exp_f32 v114, v114
    v_exp_f32 v115, v115
    v_exp_f32 v116, v116
    v_mfma_f32_32x32x16_bf16 v[96:111], v[196:199], v[208:211], v[128:143]
    v_exp_f32 v117, v117
    v_exp_f32 v118, v118
    v_exp_f32 v119, v119
    v_exp_f32 v120, v120
    v_exp_f32 v121, v121
    v_smfmac_f32_32x32x32_bf16 v[176:191], v[56:59], v[112:119], v236
    v_exp_f32 v122, v122
    v_exp_f32 v123, v123
    v_exp_f32 v124, v124
    v_exp_f32 v125, v125
    v_exp_f32 v126, v126
    v_exp_f32 v127, v127
    v_exp_f32 v96, v96
    v_exp_f32 v97, v97
    v_smfmac_f32_32x32x32_bf16 v[176:191], v[60:63], v[120:127], v236
    v_exp_f32 v98, v98
    v_exp_f32 v99, v99
    v_exp_f32 v100, v100
    v_mfma_f32_32x32x16_bf16 v[112:127], v[196:199], v[212:215], v[144:159]
    v_exp_f32 v101, v101
    v_exp_f32 v102, v102
    v_exp_f32 v103, v103
    v_exp_f32 v104, v104
    v_exp_f32 v105, v105
    v_smfmac_f32_32x32x32_bf16 v[160:175], v[64:67], v[96:103], v236
    v_exp_f32 v106, v106
    v_exp_f32 v107, v107
    v_exp_f32 v108, v108
    v_exp_f32 v109, v109
    v_exp_f32 v110, v110
    v_exp_f32 v111, v111
    v_exp_f32 v112, v112
    v_exp_f32 v113, v113
    v_smfmac_f32_32x32x32_bf16 v[160:175], v[68:71], v[104:111], v236
    s_waitcnt lgkmcnt(0)
    v_exp_f32 v114, v114
    v_exp_f32 v115, v115
    v_exp_f32 v116, v116
    v_mfma_f32_32x32x16_bf16 v[96:111], v[200:203], v[208:211], v[128:143]
    v_exp_f32 v117, v117
    v_exp_f32 v118, v118
    v_exp_f32 v119, v119
    v_exp_f32 v120, v120
    v_exp_f32 v121, v121
    v_smfmac_f32_32x32x32_bf16 v[176:191], v[64:67], v[112:119], v236
    v_exp_f32 v122, v122
    v_exp_f32 v123, v123
    v_exp_f32 v124, v124
    v_exp_f32 v125, v125
    v_exp_f32 v126, v126
    v_exp_f32 v127, v127
    s_barrier
    v_exp_f32 v96, v96
    v_exp_f32 v97, v97
    v_smfmac_f32_32x32x32_bf16 v[176:191], v[68:71], v[120:127], v236
    s_mov_b64 exec, s[64:65]
    ds_read_b128 v[56:59], v217 offset:9216
    ds_read_b128 v[60:63], v217 offset:9728
    ds_read_b128 v[64:67], v217 offset:11264
    ds_read_b128 v[68:71], v217 offset:11776
    s_mov_b64 exec, -1
    v_exp_f32 v98, v98
    v_exp_f32 v99, v99
    v_exp_f32 v100, v100
    v_mfma_f32_32x32x16_bf16 v[112:127], v[200:203], v[212:215], v[144:159]
    ds_read_b128 v[192:195], v216 offset:8192
    ds_read_b128 v[196:199], v216 offset:10240
    v_exp_f32 v101, v101
    v_exp_f32 v102, v102
    v_exp_f32 v103, v103
    v_exp_f32 v104, v104
    v_exp_f32 v105, v105
    v_smfmac_f32_32x32x32_bf16 v[160:175], v[72:75], v[96:103], v236
    v_exp_f32 v106, v106
    v_exp_f32 v107, v107
    v_exp_f32 v108, v108
    v_exp_f32 v109, v109
    v_exp_f32 v110, v110
    v_exp_f32 v111, v111
    v_exp_f32 v112, v112
    v_exp_f32 v113, v113
    v_smfmac_f32_32x32x32_bf16 v[160:175], v[76:79], v[104:111], v236
    v_exp_f32 v114, v114
    v_exp_f32 v115, v115
    v_exp_f32 v116, v116
    v_mfma_f32_32x32x16_bf16 v[96:111], v[204:207], v[208:211], v[128:143]
    v_exp_f32 v117, v117
    v_exp_f32 v118, v118
    v_exp_f32 v119, v119
    v_exp_f32 v120, v120
    v_exp_f32 v121, v121
    v_smfmac_f32_32x32x32_bf16 v[176:191], v[72:75], v[112:119], v236
    v_exp_f32 v122, v122
    v_exp_f32 v123, v123
    v_exp_f32 v124, v124
    v_exp_f32 v125, v125
    v_exp_f32 v126, v126
    v_exp_f32 v127, v127
    v_exp_f32 v96, v96
    v_exp_f32 v97, v97
    v_smfmac_f32_32x32x32_bf16 v[176:191], v[76:79], v[120:127], v236
    v_exp_f32 v98, v98
    v_exp_f32 v99, v99
    v_exp_f32 v100, v100
    v_mfma_f32_32x32x16_bf16 v[112:127], v[204:207], v[212:215], v[144:159]
    v_exp_f32 v101, v101
    v_exp_f32 v102, v102
    v_exp_f32 v103, v103
    v_exp_f32 v104, v104
    v_exp_f32 v105, v105
    v_smfmac_f32_32x32x32_bf16 v[160:175], v[80:83], v[96:103], v236
    v_exp_f32 v106, v106
    v_exp_f32 v107, v107
    v_exp_f32 v108, v108
    v_exp_f32 v109, v109
    v_exp_f32 v110, v110
    v_exp_f32 v111, v111
    v_exp_f32 v112, v112
    v_exp_f32 v113, v113
    v_smfmac_f32_32x32x32_bf16 v[160:175], v[84:87], v[104:111], v236
    s_waitcnt lgkmcnt(0)
    v_exp_f32 v114, v114
    v_exp_f32 v115, v115
    v_exp_f32 v116, v116
    v_mfma_f32_32x32x16_bf16 v[96:111], v[192:195], v[208:211], v[128:143]
    v_exp_f32 v117, v117
    v_exp_f32 v118, v118
    v_exp_f32 v119, v119
    v_exp_f32 v120, v120
    v_exp_f32 v121, v121
    v_smfmac_f32_32x32x32_bf16 v[176:191], v[80:83], v[112:119], v236
    v_exp_f32 v122, v122
    v_exp_f32 v123, v123
    v_exp_f32 v124, v124
    v_exp_f32 v125, v125
    v_exp_f32 v126, v126
    v_exp_f32 v127, v127
    v_exp_f32 v96, v96
    v_exp_f32 v97, v97
    v_smfmac_f32_32x32x32_bf16 v[176:191], v[84:87], v[120:127], v236
    s_mov_b64 exec, s[64:65]
    ds_read_b128 v[72:75], v217 offset:13312
    ds_read_b128 v[76:79], v217 offset:13824
    ds_read_b128 v[80:83], v217 offset:15360
    ds_read_b128 v[84:87], v217 offset:15872
    s_mov_b64 exec, -1
    v_exp_f32 v98, v98
    v_exp_f32 v99, v99
    v_exp_f32 v100, v100
    v_mfma_f32_32x32x16_bf16 v[112:127], v[192:195], v[212:215], v[144:159]
    ds_read_b128 v[200:203], v216 offset:12288
    ds_read_b128 v[204:207], v216 offset:14336
    v_exp_f32 v101, v101
    v_exp_f32 v102, v102
    v_exp_f32 v103, v103
    v_exp_f32 v104, v104
    v_exp_f32 v105, v105
    v_smfmac_f32_32x32x32_bf16 v[160:175], v[56:59], v[96:103], v236
    v_exp_f32 v106, v106
    v_exp_f32 v107, v107
    v_exp_f32 v108, v108
    v_exp_f32 v109, v109
    v_exp_f32 v110, v110
    v_exp_f32 v111, v111
    v_exp_f32 v112, v112
    v_exp_f32 v113, v113
    v_smfmac_f32_32x32x32_bf16 v[160:175], v[60:63], v[104:111], v236
    v_exp_f32 v114, v114
    v_exp_f32 v115, v115
    v_exp_f32 v116, v116
    v_mfma_f32_32x32x16_bf16 v[96:111], v[196:199], v[208:211], v[128:143]
    v_exp_f32 v117, v117
    v_exp_f32 v118, v118
    v_exp_f32 v119, v119
    v_exp_f32 v120, v120
    v_exp_f32 v121, v121
    v_smfmac_f32_32x32x32_bf16 v[176:191], v[56:59], v[112:119], v236
    v_exp_f32 v122, v122
    v_exp_f32 v123, v123
    v_exp_f32 v124, v124
    v_exp_f32 v125, v125
    v_exp_f32 v126, v126
    v_exp_f32 v127, v127
    v_exp_f32 v96, v96
    v_exp_f32 v97, v97
    v_smfmac_f32_32x32x32_bf16 v[176:191], v[60:63], v[120:127], v236
    v_exp_f32 v98, v98
    v_exp_f32 v99, v99
    v_exp_f32 v100, v100
    v_mfma_f32_32x32x16_bf16 v[112:127], v[196:199], v[212:215], v[144:159]
    v_exp_f32 v101, v101
    v_exp_f32 v102, v102
    v_exp_f32 v103, v103
    v_exp_f32 v104, v104
    v_exp_f32 v105, v105
    v_smfmac_f32_32x32x32_bf16 v[160:175], v[64:67], v[96:103], v236
    v_exp_f32 v106, v106
    v_exp_f32 v107, v107
    v_exp_f32 v108, v108
    v_exp_f32 v109, v109
    v_exp_f32 v110, v110
    v_exp_f32 v111, v111
    v_exp_f32 v112, v112
    v_exp_f32 v113, v113
    v_smfmac_f32_32x32x32_bf16 v[160:175], v[68:71], v[104:111], v236
    s_waitcnt lgkmcnt(0)
    v_exp_f32 v114, v114
    v_exp_f32 v115, v115
    v_exp_f32 v116, v116
    v_mfma_f32_32x32x16_bf16 v[96:111], v[200:203], v[208:211], v[128:143]
    v_exp_f32 v117, v117
    v_exp_f32 v118, v118
    v_exp_f32 v119, v119
    v_exp_f32 v120, v120
    v_exp_f32 v121, v121
    v_smfmac_f32_32x32x32_bf16 v[176:191], v[64:67], v[112:119], v236
    v_exp_f32 v122, v122
    v_exp_f32 v123, v123
    v_exp_f32 v124, v124
    v_exp_f32 v125, v125
    v_exp_f32 v126, v126
    v_exp_f32 v127, v127
    s_add_u32 s55, s55, 1
    s_branch L_att_top
L_att_done:
    ds_read_b32 v92, v216
    v_smfmac_f32_32x32x32_bf16 v[176:191], v[84:87], v[120:127], v236
L_att_fin:
    v_rcp_f32 v8, v168
    s_mov_b32 s51, 0x7e000000
    v_maximum3_f32 v9, abs(v160), abs(v161), abs(v162)
    v_maximum3_f32 v9, v9, abs(v163), abs(v164)
    v_maximum3_f32 v9, v9, abs(v165), abs(v166)
    v_maximum3_f32 v9, v9, abs(v167), v168
    v_pk_mul_f32 v[160:161], v[160:161], v[8:9] op_sel_hi:[1,0]
    v_pk_mul_f32 v[162:163], v[162:163], v[8:9] op_sel_hi:[1,0]
    v_pk_mul_f32 v[164:165], v[164:165], v[8:9] op_sel_hi:[1,0]
    v_pk_mul_f32 v[166:167], v[166:167], v[8:9] op_sel_hi:[1,0]
    v_cvt_pk_bf16_f32 v224, v160, v161
    v_cvt_pk_bf16_f32 v225, v162, v163
    v_cvt_pk_bf16_f32 v226, v164, v165
    v_cvt_pk_bf16_f32 v227, v166, v167
    v_rcp_f32 v10, v184
    s_waitcnt lgkmcnt(0)
    v_readfirstlane_b32 s52, v92
    v_maximum3_f32 v11, abs(v176), abs(v177), abs(v178)
    v_maximum3_f32 v11, v11, abs(v179), abs(v180)
    v_maximum3_f32 v11, v11, abs(v181), abs(v182)
    v_maximum3_f32 v11, v11, abs(v183), v184
    v_pk_mul_f32 v[176:177], v[176:177], v[10:11] op_sel_hi:[1,0]
    v_pk_mul_f32 v[178:179], v[178:179], v[10:11] op_sel_hi:[1,0]
    v_pk_mul_f32 v[180:181], v[180:181], v[10:11] op_sel_hi:[1,0]
    v_pk_mul_f32 v[182:183], v[182:183], v[10:11] op_sel_hi:[1,0]
    v_cvt_pk_bf16_f32 v228, v176, v177
    v_cvt_pk_bf16_f32 v229, v178, v179
    v_cvt_pk_bf16_f32 v230, v180, v181
    v_cvt_pk_bf16_f32 v231, v182, v183
    v_maximum3_f32 v9, v9, v11, v11
    v_cmp_nle_f32 vcc, v9, s51
    s_cmp_eq_u32 s52, 1
    s_cbranch_vccnz L_fallback
L_att_ok:
    s_cbranch_scc0 L_st_slow
    buffer_store_dwordx4 v[224:227], v1, s[40:43], s70 offen
    buffer_store_dwordx4 v[228:231], v1, s[40:43], s70 offen offset:1024
L_st_j:
    ds_read_b64_tr_b16 v[96:97], v240 offset:0
    ds_read_b64_tr_b16 v[98:99], v240 offset:1024
    ds_read_b64_tr_b16 v[100:101], v241 offset:0
    ds_read_b64_tr_b16 v[102:103], v241 offset:1024
    ds_read_b64_tr_b16 v[104:105], v240 offset:2048
    ds_read_b64_tr_b16 v[106:107], v240 offset:3072
    ds_read_b64_tr_b16 v[108:109], v241 offset:2048
    ds_read_b64_tr_b16 v[110:111], v241 offset:3072
    ds_read_b64_tr_b16 v[112:113], v240 offset:4096
    ds_read_b64_tr_b16 v[114:115], v240 offset:5120
    ds_read_b64_tr_b16 v[116:117], v241 offset:4096
    ds_read_b64_tr_b16 v[118:119], v241 offset:5120
    ds_read_b64_tr_b16 v[120:121], v240 offset:6144
    ds_read_b64_tr_b16 v[122:123], v240 offset:7168
    ds_read_b64_tr_b16 v[124:125], v241 offset:6144
    ds_read_b64_tr_b16 v[126:127], v241 offset:7168
    ds_read_b64_tr_b16 v[128:129], v240 offset:8192
    ds_read_b64_tr_b16 v[130:131], v240 offset:9216
    ds_read_b64_tr_b16 v[132:133], v241 offset:8192
    ds_read_b64_tr_b16 v[134:135], v241 offset:9216
    ds_read_b64_tr_b16 v[136:137], v240 offset:10240
    ds_read_b64_tr_b16 v[138:139], v240 offset:11264
    ds_read_b64_tr_b16 v[140:141], v241 offset:10240
    ds_read_b64_tr_b16 v[142:143], v241 offset:11264
    ds_read_b64_tr_b16 v[144:145], v240 offset:12288
    ds_read_b64_tr_b16 v[146:147], v240 offset:13312
    ds_read_b64_tr_b16 v[148:149], v241 offset:12288
    ds_read_b64_tr_b16 v[150:151], v241 offset:13312
    ds_read_b64_tr_b16 v[152:153], v240 offset:14336
    ds_read_b64_tr_b16 v[154:155], v240 offset:15360
    ds_read_b64_tr_b16 v[156:157], v241 offset:14336
    ds_read_b64_tr_b16 v[158:159], v241 offset:15360
    v_xor_b32 v81, 32, v242
    v_xor_b32 v82, 64, v242
    v_xor_b32 v83, 96, v242
    v_xor_b32 v84, 128, v242
    v_xor_b32 v85, 160, v242
    v_xor_b32 v86, 192, v242
    v_xor_b32 v87, 224, v242
    v_xor_b32 v88, 16, v243
    s_mov_b32 s69, 20000
    s_add_u32 s52, s66, 4096
    s_add_u32 s53, s66, 32768
    s_add_u32 s54, s66, 36864
    buffer_load_dwordx4 v[16:19], v1, s[40:43], s66 offen sc1
    buffer_load_dwordx4 v[20:23], v1, s[40:43], s66 offen offset:1024 sc1
    buffer_load_dwordx4 v[24:27], v1, s[40:43], s66 offen offset:2048 sc1
    buffer_load_dwordx4 v[28:31], v1, s[40:43], s66 offen offset:3072 sc1
    buffer_load_dwordx4 v[32:35], v1, s[40:43], s52 offen sc1
    buffer_load_dwordx4 v[36:39], v1, s[40:43], s52 offen offset:1024 sc1
    buffer_load_dwordx4 v[40:43], v1, s[40:43], s52 offen offset:2048 sc1
    buffer_load_dwordx4 v[44:47], v1, s[40:43], s52 offen offset:3072 sc1
    s_mov_b32 s55, 2
L_tail_go:
    s_waitcnt lgkmcnt(0)
    s_waitcnt vmcnt(4)
L_tg0:
    v_max3_u32 v8, v16, v17, v18
    v_max3_u32 v9, v19, v20, v21
    v_max3_u32 v8, v8, v22, v23
    v_max3_u32 v9, v9, v24, v25
    v_max3_u32 v8, v8, v26, v27
    v_max3_u32 v9, v9, v28, v29
    v_max3_u32 v8, v8, v30, v31
    v_max_u32 v8, v8, v9
    v_cmp_eq_u32 vcc, -1, v8
    s_cbranch_vccnz L_tr0
L_tk0:
    buffer_load_dwordx4 v[48:51], v1, s[40:43], s53 offen sc1
    buffer_load_dwordx4 v[52:55], v1, s[40:43], s53 offen offset:1024 sc1
    buffer_load_dwordx4 v[56:59], v1, s[40:43], s53 offen offset:2048 sc1
    buffer_load_dwordx4 v[60:63], v1, s[40:43], s53 offen offset:3072 sc1
    v_mfma_f32_32x32x16_bf16 v[160:175], v[96:99], v[16:19], 0
    v_mfma_f32_32x32x16_bf16 v[176:191], v[100:103], v[16:19], 0
    v_mfma_f32_32x32x16_bf16 v[160:175], v[104:107], v[20:23], v[160:175]
    v_mfma_f32_32x32x16_bf16 v[176:191], v[108:111], v[20:23], v[176:191]
    v_mfma_f32_32x32x16_bf16 v[160:175], v[112:115], v[24:27], v[160:175]
    v_mfma_f32_32x32x16_bf16 v[176:191], v[116:119], v[24:27], v[176:191]
    v_mfma_f32_32x32x16_bf16 v[160:175], v[120:123], v[28:31], v[160:175]
    v_mfma_f32_32x32x16_bf16 v[176:191], v[124:127], v[28:31], v[176:191]
    s_waitcnt vmcnt(4)
L_tg1:
    v_max3_u32 v8, v32, v33, v34
    v_max3_u32 v9, v35, v36, v37
    v_max3_u32 v8, v8, v38, v39
    v_max3_u32 v9, v9, v40, v41
    v_max3_u32 v8, v8, v42, v43
    v_max3_u32 v9, v9, v44, v45
    v_max3_u32 v8, v8, v46, v47
    v_max_u32 v8, v8, v9
    v_cmp_eq_u32 vcc, -1, v8
    s_cbranch_vccnz L_tr1
L_tk1:
    buffer_load_dwordx4 v[64:67], v1, s[40:43], s54 offen sc1
    buffer_load_dwordx4 v[68:71], v1, s[40:43], s54 offen offset:1024 sc1
    buffer_load_dwordx4 v[72:75], v1, s[40:43], s54 offen offset:2048 sc1
    buffer_load_dwordx4 v[76:79], v1, s[40:43], s54 offen offset:3072 sc1
    v_mfma_f32_32x32x16_bf16 v[160:175], v[128:131], v[32:35], v[160:175]
    v_mfma_f32_32x32x16_bf16 v[176:191], v[132:135], v[32:35], v[176:191]
    v_mfma_f32_32x32x16_bf16 v[160:175], v[136:139], v[36:39], v[160:175]
    v_mfma_f32_32x32x16_bf16 v[176:191], v[140:143], v[36:39], v[176:191]
    v_mfma_f32_32x32x16_bf16 v[160:175], v[144:147], v[40:43], v[160:175]
    v_mfma_f32_32x32x16_bf16 v[176:191], v[148:151], v[40:43], v[176:191]
    v_mfma_f32_32x32x16_bf16 v[160:175], v[152:155], v[44:47], v[160:175]
    v_mfma_f32_32x32x16_bf16 v[176:191], v[156:159], v[44:47], v[176:191]
    s_waitcnt vmcnt(4)
L_tg2:
    v_max3_u32 v8, v48, v49, v50
    v_max3_u32 v9, v51, v52, v53
    v_max3_u32 v8, v8, v54, v55
    v_max3_u32 v9, v9, v56, v57
    v_max3_u32 v8, v8, v58, v59
    v_max3_u32 v9, v9, v60, v61
    v_max3_u32 v8, v8, v62, v63
    v_max_u32 v8, v8, v9
    v_cmp_eq_u32 vcc, -1, v8
    s_cbranch_vccnz L_tr2
L_tk2:
    s_barrier
    v_mfma_f32_32x32x16_bf16 v[192:207], v[96:99], v[48:51], 0
    ds_write_b128 v242, v[160:163]
    v_mfma_f32_32x32x16_bf16 v[208:223], v[100:103], v[48:51], 0
    ds_write_b128 v81, v[164:167]
    v_mfma_f32_32x32x16_bf16 v[192:207], v[104:107], v[52:55], v[192:207]
    ds_write_b128 v82, v[168:171]
    v_mfma_f32_32x32x16_bf16 v[208:223], v[108:111], v[52:55], v[208:223]
    ds_write_b128 v83, v[172:175]
    v_mfma_f32_32x32x16_bf16 v[192:207], v[112:115], v[56:59], v[192:207]
    ds_write_b128 v84, v[176:179]
    v_mfma_f32_32x32x16_bf16 v[208:223], v[116:119], v[56:59], v[208:223]
    ds_write_b128 v85, v[180:183]
    v_mfma_f32_32x32x16_bf16 v[192:207], v[120:123], v[60:63], v[192:207]
    ds_write_b128 v86, v[184:187]
    v_mfma_f32_32x32x16_bf16 v[208:223], v[124:127], v[60:63], v[208:223]
    ds_write_b128 v87, v[188:191]
    s_waitcnt vmcnt(0)
L_tg3:
    v_max3_u32 v8, v64, v65, v66
    v_max3_u32 v9, v67, v68, v69
    v_max3_u32 v8, v8, v70, v71
    v_max3_u32 v9, v9, v72, v73
    v_max3_u32 v8, v8, v74, v75
    v_max3_u32 v9, v9, v76, v77
    v_max3_u32 v8, v8, v78, v79
    v_max_u32 v8, v8, v9
    v_cmp_eq_u32 vcc, -1, v8
    s_cbranch_vccnz L_tr3
L_tk3:
    v_mfma_f32_32x32x16_bf16 v[192:207], v[128:131], v[64:67], v[192:207]
    v_mfma_f32_32x32x16_bf16 v[192:207], v[136:139], v[68:71], v[192:207]
    v_mfma_f32_32x32x16_bf16 v[192:207], v[144:147], v[72:75], v[192:207]
    v_mfma_f32_32x32x16_bf16 v[192:207], v[152:155], v[76:79], v[192:207]
    v_mfma_f32_32x32x16_bf16 v[208:223], v[132:135], v[64:67], v[208:223]
    v_mfma_f32_32x32x16_bf16 v[208:223], v[140:143], v[68:71], v[208:223]
    v_mfma_f32_32x32x16_bf16 v[208:223], v[148:151], v[72:75], v[208:223]
    v_mfma_f32_32x32x16_bf16 v[208:223], v[156:159], v[76:79], v[208:223]
    s_nop 7
L_tail_wr:
    ds_write_b128 v242, v[192:195] offset:8192
    ds_write_b128 v81, v[196:199] offset:8192
    ds_write_b128 v82, v[200:203] offset:8192
    ds_write_b128 v83, v[204:207] offset:8192
    ds_write_b128 v84, v[208:211] offset:8192
    ds_write_b128 v85, v[212:215] offset:8192
    ds_write_b128 v86, v[216:219] offset:8192
    ds_write_b128 v87, v[220:223] offset:8192
    s_waitcnt lgkmcnt(0)
    s_barrier
L_red:
    ds_read_b128 v[96:99], v243 offset:0
    ds_read_b128 v[100:103], v88 offset:0
    ds_read_b128 v[104:107], v243 offset:16384
    ds_read_b128 v[108:111], v88 offset:16384
    ds_read_b128 v[112:115], v243 offset:32768
    ds_read_b128 v[116:119], v88 offset:32768
    ds_read_b128 v[120:123], v243 offset:49152
    ds_read_b128 v[124:127], v88 offset:49152
    s_waitcnt lgkmcnt(4)
    v_pk_add_f32 v[96:97], v[96:97], v[104:105]
    v_pk_add_f32 v[98:99], v[98:99], v[106:107]
    v_pk_add_f32 v[100:101], v[100:101], v[108:109]
    v_pk_add_f32 v[102:103], v[102:103], v[110:111]
    s_waitcnt lgkmcnt(0)
    v_pk_add_f32 v[112:113], v[112:113], v[120:121]
    v_pk_add_f32 v[114:115], v[114:115], v[122:123]
    v_pk_add_f32 v[116:117], v[116:117], v[124:125]
    v_pk_add_f32 v[118:119], v[118:119], v[126:127]
    v_pk_add_f32 v[96:97], v[96:97], v[112:113]
    v_pk_add_f32 v[98:99], v[98:99], v[114:115]
    v_pk_add_f32 v[100:101], v[100:101], v[116:117]
    v_pk_add_f32 v[102:103], v[102:103], v[118:119]
    v_cvt_pk_bf16_f32 v16, v96, v97
    v_cvt_pk_bf16_f32 v17, v98, v99
    v_cvt_pk_bf16_f32 v18, v100, v101
    v_cvt_pk_bf16_f32 v19, v102, v103
    buffer_store_dwordx4 v[16:19], v244, s[36:39], s67 offen nt
    s_cmp_eq_u32 s55, 2
    s_cbranch_scc1 L_fin
    s_add_u32 s55, s55, 1
    s_cmp_eq_u32 s55, 1
    s_cselect_b32 s51, 1, 8
    s_cselect_b32 s52, 64, 1
    s_lshl_b32 s52, s52, 10
    s_lshl_b32 s51, s51, 13
    v_add_u32 v243, s51, v243
    v_add_u32 v88, s51, v88
    s_add_u32 s67, s67, s52
    s_cmp_eq_u32 s55, 1
    s_cbranch_scc1 L_red
    s_barrier
    s_branch L_red
L_fin:
L_end:
    s_endpgm
    .p2align 6
L_X:
    s_mov_b32 s26, 0x80000
    s_mov_b32 s27, 0x20000
    s_mov_b32 s10, 0x200000
    s_mov_b32 s11, 0x20000
    s_mov_b32 s14, 0x180000
    s_mov_b32 s15, 0x20000
    s_or_b32 s52, s2, s48
    s_cbranch_scc1 L_nonon
    s_waitcnt lgkmcnt(0)
    s_lshl_b64 s[100:101], s[100:101], 5
    s_or_b32 s100, s100, 1
    v_mov_b32 v90, s100
    v_mov_b32 v91, s101
    s_mov_b64 exec, 1
    global_store_dwordx2 v246, v[90:91], s[44:45] sc1
    s_mov_b64 exec, -1
L_nonon:
    v_and_b32 v11, 1, v15
    v_lshlrev_b32 v11, 2, v11
    v_xor_b32 v11, v11, v10
    v_lshlrev_b32 v11, 4, v11
    v_lshl_add_u32 v2, v9, 10, v11
    v_add_u32 v239, 7168, v2
    v_mul_u32_u24 v3, 3072, v9
    v_add_u32 v3, v3, v11
    s_lshl_b32 s63, s48, 11
    s_lshl_b32 s51, s4, 16
    s_lshl_b32 s53, s48, 14
    s_add_u32 s51, s51, s53
    s_add_u32 s51, s51, s73
    s_waitcnt lgkmcnt(0)
    s_barrier
    s_add_u32 m0, s63, 8192
    s_and_b32 s51, s51, 0x7ffff
    buffer_load_dwordx4 v2, s[24:27], s51 offen lds
    buffer_load_dwordx4 v239, s[24:27], s51 offen offset:1024 lds
    s_add_u32 s51, s51, 65536
    s_add_u32 m0, s63, 24576
    s_and_b32 s51, s51, 0x7ffff
    buffer_load_dwordx4 v2, s[24:27], s51 offen lds
    buffer_load_dwordx4 v239, s[24:27], s51 offen offset:1024 lds
    s_add_u32 s51, s51, 65536
    s_add_u32 m0, s63, 40960
    s_and_b32 s51, s51, 0x7ffff
    buffer_load_dwordx4 v2, s[24:27], s51 offen lds
    buffer_load_dwordx4 v239, s[24:27], s51 offen offset:1024 lds
    s_add_u32 s51, s51, 65536
    s_add_u32 m0, s63, 57344
    s_and_b32 s51, s51, 0x7ffff
    buffer_load_dwordx4 v2, s[24:27], s51 offen lds
    buffer_load_dwordx4 v239, s[24:27], s51 offen offset:1024 lds
    s_add_u32 s51, s51, 65536
    s_add_u32 m0, s63, 73728
    s_and_b32 s51, s51, 0x7ffff
    buffer_load_dwordx4 v2, s[24:27], s51 offen lds
    buffer_load_dwordx4 v239, s[24:27], s51 offen offset:1024 lds
    s_add_u32 s51, s51, 65536
    s_add_u32 m0, s63, 90112
    s_and_b32 s51, s51, 0x7ffff
    buffer_load_dwordx4 v2, s[24:27], s51 offen lds
    buffer_load_dwordx4 v239, s[24:27], s51 offen offset:1024 lds
    s_add_u32 s51, s51, 65536
    s_add_u32 m0, s63, 106496
    s_and_b32 s51, s51, 0x7ffff
    buffer_load_dwordx4 v2, s[24:27], s51 offen lds
    buffer_load_dwordx4 v239, s[24:27], s51 offen offset:1024 lds
    s_add_u32 s51, s51, 65536
    s_add_u32 m0, s63, 122880
    s_and_b32 s51, s51, 0x7ffff
    buffer_load_dwordx4 v2, s[24:27], s51 offen lds
    buffer_load_dwordx4 v239, s[24:27], s51 offen offset:1024 lds
    v_and_b32 v5, 31, v0
    v_lshrrev_b32 v6, 5, v0
    v_and_b32 v7, 15, v0
    v_lshrrev_b32 v235, 2, v7
    v_lshl_add_u32 v235, v6, 3, v235
    v_lshlrev_b32 v235, 7, v235
    v_and_b32 v248, 8, v7
    v_lshl_add_u32 v235, v248, 3, v235
    v_and_b32 v248, 16, v0
    v_lshl_add_u32 v235, v248, 1, v235
    v_and_b32 v248, 3, v0
    v_lshl_add_u32 v235, v248, 3, v235
    s_lshl_b32 s61, s75, 12
    s_add_u32 s3, s61, 131072
    v_add_u32 v238, s3, v1
    v_mov_b32 v236, 0xdddddddd
    s_mov_b32 s72, 0
    v_bfe_u32 v14, v5, 1, 3
    v_xor_b32 v14, v14, v6
    v_lshlrev_b32 v14, 4, v14
    s_and_b32 s3, s48, 1
    s_lshl_b32 s3, s3, 12
    v_lshl_add_u32 v56, v5, 7, v14
    v_add_u32 v56, s3, v56
    v_xor_b32 v57, 32, v56
    v_xor_b32 v58, 64, v56
    v_xor_b32 v59, 96, v56
    s_and_b32 s7, s48, 2
    s_lshl_b32 s7, s7, 5
    v_xor_b32 v64, s7, v235
    v_add_u32 v64, 8192, v64
    v_add_u32 v65, 65536, v64
    s_mov_b32 s74, 0x3eb8aa3b
    v_add_u32 v60, 65536, v56
    v_add_u32 v61, 65536, v57
    v_add_u32 v62, 65536, v58
    v_add_u32 v63, 65536, v59
    s_mov_b32 s58, 0
    s_lshl_b32 s63, s48, 11
    s_lshl_b32 s54, s49, 2
    s_add_u32 s51, s54, s48
    s_lshl_b32 s51, s51, 14
    v_add_u32 v4, s51, v12
    v_add_u32 v253, s51, v13
    s_mul_i32 s51, s48, 49152
    s_add_u32 s51, s51, s73
    v_add_u32 v3, s51, v3
    v_add_u32 v252, 23552, v3
    s_lshr_b32 s52, s49, 2
    s_lshl_b32 s60, s52, 14
    s_add_u32 s60, s60, s61
    v_lshlrev_b32 v237, 3, v0
    v_add_u32 v237, 0x44000, v237
    v_lshlrev_b32 v245, 6, v5
    s_lshl_b32 s53, s49, 11
    s_add_u32 s53, s53, 0x48000
    v_add_u32 v245, s53, v245
    s_lshl_b32 s53, s52, 2
    s_add_u32 s53, s53, s48
    s_lshl_b32 s53, s53, 3
    v_and_b32 v234, 7, v0
    v_add_u32 v234, s53, v234
    v_and_b32 v232, 8, v0
    v_lshlrev_b32 v232, 2, v232
    v_add3_u32 v232, v232, v234, 32
    v_and_b32 v232, 255, v232
    v_lshlrev_b32 v232, 6, v232
    v_add_u32 v232, 0x40000, v232
    v_lshlrev_b32 v234, 6, v234
    v_add_u32 v234, 0x40000, v234
    s_mov_b32 s64, 512
    s_mov_b32 s65, 1024
    s_mov_b32 s55, 1536
    s_lshl_b32 s62, s48, 13
    s_lshl_b32 s68, s48, 14
    s_add_u32 s68, s68, s73
    s_lshl_b32 s53, s49, 17
    s_add_u32 s68, s68, s53
    s_mov_b32 s18, 0x80000
    s_mov_b32 s19, 0x20000
    s_mov_b32 s34, 0x80000
    s_mov_b32 s35, 0x20000
    s_getreg_b32 s30, hwreg(HW_REG_XCC_ID, 0, 4)
    s_lshl_b32 s30, s30, 1
    s_and_b32 s51, s48, 1
    s_lshl_b32 s51, s51, 12
    s_lshr_b32 s52, s48, 1
    s_lshl_b32 s53, s52, 11
    s_add_u32 s51, s51, s53
    s_add_u32 s51, s51, 65536
    v_add_u32 v72, s51, v1
    s_lshl_b32 s51, s49, 3
    s_add_u32 s51, s51, s50
    s_lshl_b32 s56, s51, 13
    s_add_u32 s56, s56, s53
    s_add_u32 s56, s56, 0x600000
    s_lshl_b32 s57, s51, 1
    s_add_u32 s57, s57, s52
    s_lshl_b32 s57, s57, 6
    s_add_u32 s57, s57, 0x60000
    s_cmp_eq_u32 s49, 0
    s_cselect_b32 s53, 0, 8
    s_sub_u32 s51, s51, s53
    s_lshl_b32 s53, s53, 7
    s_sub_u32 s53, s57, s53
    v_mov_b32 v233, s53
    s_lshl_b32 s31, s51, 13
    s_lshl_b32 s53, s48, 10
    s_add_u32 s31, s31, s53
    s_add_u32 s31, s31, 0x600000
    v_mov_b32 v76, 0x3f803f80
    v_mov_b32 v77, 0x3f803f80
    s_lshl_b32 s52, s48, 10
    s_add_u32 s53, s52, 98304
    s_add_u32 s52, s52, 65536
    v_add_u32 v73, s52, v1
    v_and_b32 v8, 1, v0
    v_lshlrev_b32 v8, 5, v8
    v_lshl_add_u32 v8, v6, 3, v8
    v_lshrrev_b32 v9, 2, v7
    v_add_u32 v8, v8, v9
    v_lshlrev_b32 v8, 4, v8
    v_and_b32 v9, 2, v0
    v_lshl_add_u32 v8, v9, 2, v8
    v_add_u32 v74, s52, v8
    v_mov_b32 v75, s53
    v_lshl_add_u32 v247, v0, 3, v75
    v_and_b32 v8, 16, v0
    v_cmp_ne_u32 vcc, 0, v8
    v_add_u32 v78, 16384, v74
    v_add_u32 v79, 20480, v74
    v_add_u32 v80, 28672, v74
    v_cndmask_b32 v78, v78, v75, vcc
    v_cndmask_b32 v79, v79, v75, vcc
    v_cndmask_b32 v80, v80, v75, vcc
    s_lshl_b32 s51, s49, 6
    s_lshl_b32 s52, s50, 2
    s_add_u32 s52, s52, s48
    s_add_u32 s51, s51, s52
    s_lshl_b32 s51, s51, 10
    s_add_u32 s70, s51, 0x100000
    s_add_u32 s71, s70, 32768
    s_lshl_b32 s51, s49, 5
    s_add_u32 s51, s51, s52
    s_lshl_b32 s51, s51, 6
    s_add_u32 s5, s51, 0x48000
    v_mov_b32 v248, -1
    v_mov_b32 v249, -1
    v_mov_b32 v250, -1
    v_mov_b32 v251, -1
    s_waitcnt vmcnt(0)
    s_barrier
    s_mov_b32 s38, 0x400000
    s_mov_b32 s39, 0x20000
    s_lshr_b32 s7, s48, 2
    s_lshl_b32 s6, s48, 14
    v_lshlrev_b32 v8, 9, v6
    v_sub_u32 v240, v235, v8
    v_add_u32 v240, s6, v240
    v_xor_b32 v241, 64, v240
    v_xor_b32 v8, v6, v7
    v_lshlrev_b32 v8, 4, v8
    v_lshl_add_u32 v8, v5, 8, v8
    v_add_u32 v242, s6, v8
    v_lshrrev_b32 v8, 3, v0
    s_lshl_b32 s6, s75, 3
    v_add_u32 v8, s6, v8
    v_and_b32 v9, 7, v0
    v_lshlrev_b32 v10, 1, v9
    v_and_b32 v11, 15, v8
    v_xor_b32 v10, v10, v11
    v_lshlrev_b32 v10, 4, v10
    v_lshl_add_u32 v10, v8, 8, v10
    s_lshl_b32 s6, s7, 16
    v_add_u32 v243, s6, v10
    v_lshlrev_b32 v9, 4, v9
    v_lshl_add_u32 v244, v8, 11, v9
    s_lshl_b32 s67, s49, 17
    s_lshl_b32 s6, s7, 10
    s_add_u32 s67, s67, s6
    s_add_u32 s67, s67, s73
    s_lshl_b32 s66, s49, 16
    s_add_u32 s6, s75, s49
    s_and_b32 s6, s6, 3
    s_lshl_b32 s6, s6, 13
    s_add_u32 s66, s66, s6
    s_lshl_b32 s6, s7, 21
    s_add_u32 s66, s66, s6
    s_add_u32 s66, s66, 0x100000
    s_barrier
    global_load_dwordx2 v[90:91], v246, s[44:45] sc1
    buffer_load_dwordx2 v[92:93], v234, s[40:43], 0 offen sc1
    v_lshlrev_b32 v8, 2, v6
    v_sub_u32 v8, v5, v8
    v_add_u32 v8, 18, v8
    v_mov_b32 v10, 0x5555
    v_mov_b32 v11, 0
    v_lshlrev_b64 v[10:11], v8, v[10:11]
    v_not_b32 v10, v10
    v_not_b32 v11, v11
    s_mov_b32 s6, 0xff800000
    v_bfe_i32 v32, v11, 0, 1
    v_and_b32 v32, s6, v32
    v_bfe_i32 v33, v11, 1, 1
    v_and_b32 v33, s6, v33
    v_bfe_i32 v34, v11, 2, 1
    v_and_b32 v34, s6, v34
    v_bfe_i32 v35, v11, 3, 1
    v_and_b32 v35, s6, v35
    v_bfe_i32 v36, v11, 8, 1
    v_and_b32 v36, s6, v36
    v_bfe_i32 v37, v11, 9, 1
    v_and_b32 v37, s6, v37
    v_bfe_i32 v38, v11, 10, 1
    v_and_b32 v38, s6, v38
    v_bfe_i32 v39, v11, 11, 1
    v_and_b32 v39, s6, v39
    v_bfe_i32 v40, v11, 16, 1
    v_and_b32 v40, s6, v40
    v_bfe_i32 v41, v11, 17, 1
    v_and_b32 v41, s6, v41
    v_bfe_i32 v42, v11, 18, 1
    v_and_b32 v42, s6, v42
    v_bfe_i32 v43, v11, 19, 1
    v_and_b32 v43, s6, v43
    v_bfe_i32 v44, v11, 24, 1
    v_and_b32 v44, s6, v44
    v_bfe_i32 v45, v11, 25, 1
    v_and_b32 v45, s6, v45
    v_bfe_i32 v46, v11, 26, 1
    v_and_b32 v46, s6, v46
    v_bfe_i32 v47, v11, 27, 1
    v_and_b32 v47, s6, v47
    v_bfe_i32 v48, v10, 16, 1
    v_and_b32 v48, s6, v48
    v_bfe_i32 v49, v10, 17, 1
    v_and_b32 v49, s6, v49
    v_bfe_i32 v50, v10, 18, 1
    v_and_b32 v50, s6, v50
    v_bfe_i32 v51, v10, 19, 1
    v_and_b32 v51, s6, v51
    v_bfe_i32 v52, v10, 24, 1
    v_and_b32 v52, s6, v52
    v_bfe_i32 v53, v10, 25, 1
    v_and_b32 v53, s6, v53
    v_bfe_i32 v54, v10, 26, 1
    v_and_b32 v54, s6, v54
    v_bfe_i32 v55, v10, 27, 1
    v_and_b32 v55, s6, v55
    s_mov_b32 s69, 200000
    s_waitcnt vmcnt(0)
    s_branch L_chk_kv
L_rep_kv:
    global_load_dwordx2 v[90:91], v246, s[44:45] sc1
    buffer_load_dwordx2 v[92:93], v234, s[40:43], 0 offen sc1
    s_waitcnt vmcnt(0)
L_chk_kv:
    v_cmp_eq_u32 vcc, 0, v90
    v_cmp_ne_u64 s[46:47], v[90:91], v[92:93]
    s_nop 1
    s_or_b64 vcc, vcc, s[46:47]
    s_cbranch_scc0 L_nochk_kv
    s_sub_u32 s69, s69, 1
    s_cbranch_scc0 L_rep_kv
L_nochk_kv:
    s_add_u32 m0, s61, 147456
    s_and_b32 s60, s60, 0x1ffff
    buffer_load_dwordx4 v1, s[40:43], s60 offen sc1 lds
    buffer_load_dwordx4 v1, s[40:43], s60 offen offset:1024 sc1 lds
    buffer_load_dwordx4 v1, s[40:43], s60 offen offset:2048 sc1 lds
    buffer_load_dwordx4 v1, s[40:43], s60 offen offset:3072 sc1 lds
    s_add_u32 s60, s60, 16384
    global_load_dwordx2 v[90:91], v246, s[44:45] sc1
    buffer_load_dwordx2 v[92:93], v232, s[40:43], 0 offen sc1
    s_add_u32 m0, s63, 0
    s_mul_i32 s59, s58, 1536
    buffer_load_dwordx4 v4, s[8:11], s58 offen nt lds
    buffer_load_dwordx4 v253, s[8:11], s58 offen offset:1024 nt lds
    s_add_u32 m0, s63, 8192
    s_add_u32 s58, s58, 128
    buffer_load_dwordx4 v3, s[12:15], s59 offen lds
    buffer_load_dwordx4 v252, s[12:15], s59 offen offset:1024 lds
    s_add_u32 m0, s63, 16384
    s_add_u32 s59, s59, 1024
    buffer_load_dwordx4 v3, s[12:15], s59 offen lds
    buffer_load_dwordx4 v252, s[12:15], s59 offen offset:1024 lds
    s_add_u32 m0, s63, 24576
    s_add_u32 s59, s59, 1024
    buffer_load_dwordx4 v3, s[12:15], s59 offen lds
    buffer_load_dwordx4 v252, s[12:15], s59 offen offset:1024 lds
    s_and_b32 s58, s58, 1023
    v_mov_b32 v208, 0
    v_mov_b32 v16, 0
    v_mov_b32 v209, 0
    v_mov_b32 v17, 0
    v_mov_b32 v210, 0
    v_mov_b32 v18, 0
    v_mov_b32 v211, 0
    v_mov_b32 v19, 0
    v_mov_b32 v212, 0
    v_mov_b32 v20, 0
    v_mov_b32 v213, 0
    v_mov_b32 v21, 0
    v_mov_b32 v214, 0
    v_mov_b32 v22, 0
    v_mov_b32 v215, 0
    v_mov_b32 v23, 0
    v_mov_b32 v216, 0
    v_mov_b32 v24, 0
    v_mov_b32 v217, 0
    v_mov_b32 v25, 0
    v_mov_b32 v218, 0
    v_mov_b32 v26, 0
    v_mov_b32 v219, 0
    v_mov_b32 v27, 0
    v_mov_b32 v220, 0
    v_mov_b32 v28, 0
    v_mov_b32 v221, 0
    v_mov_b32 v29, 0
    v_mov_b32 v222, 0
    v_mov_b32 v30, 0
    v_mov_b32 v223, 0
    v_mov_b32 v31, 0
    s_setprio 2
    s_waitcnt vmcnt(10)
    s_barrier
    s_mov_b32 s69, 200000
    s_waitcnt vmcnt(8)
    s_branch L_chk_kv1
L_rep_kv1:
    global_load_dwordx2 v[90:91], v246, s[44:45] sc1
    buffer_load_dwordx2 v[92:93], v232, s[40:43], 0 offen sc1
    s_waitcnt vmcnt(0)
L_chk_kv1:
    v_cmp_eq_u32 vcc, 0, v90
    v_cmp_ne_u64 s[46:47], v[90:91], v[92:93]
    s_nop 1
    s_or_b64 vcc, vcc, s[46:47]
    s_cbranch_scc0 L_nochk_kv1
    s_sub_u32 s69, s69, 1
    s_cbranch_scc0 L_rep_kv1
L_nochk_kv1:
    s_add_u32 m0, s61, 131072
    s_and_b32 s60, s60, 0x1ffff
    buffer_load_dwordx4 v1, s[40:43], s60 offen sc1 lds
    buffer_load_dwordx4 v1, s[40:43], s60 offen offset:1024 sc1 lds
    buffer_load_dwordx4 v1, s[40:43], s60 offen offset:2048 sc1 lds
    buffer_load_dwordx4 v1, s[40:43], s60 offen offset:3072 sc1 lds
    s_add_u32 s60, s60, 16384
    s_add_u32 m0, s63, 32768
    s_mul_i32 s59, s58, 1536
    buffer_load_dwordx4 v4, s[8:11], s58 offen nt lds
    buffer_load_dwordx4 v253, s[8:11], s58 offen offset:1024 nt lds
    s_add_u32 m0, s63, 40960
    s_add_u32 s58, s58, 128
    buffer_load_dwordx4 v3, s[12:15], s59 offen lds
    buffer_load_dwordx4 v252, s[12:15], s59 offen offset:1024 lds
    s_add_u32 m0, s63, 49152
    s_add_u32 s59, s59, 1024
    buffer_load_dwordx4 v3, s[12:15], s59 offen lds
    buffer_load_dwordx4 v252, s[12:15], s59 offen offset:1024 lds
    s_add_u32 m0, s63, 57344
    s_add_u32 s59, s59, 1024
    buffer_load_dwordx4 v3, s[12:15], s59 offen lds
    buffer_load_dwordx4 v252, s[12:15], s59 offen offset:1024 lds
    s_and_b32 s58, s58, 1023
    s_waitcnt vmcnt(12) lgkmcnt(0)
    s_barrier
    s_setprio 0
    ds_read_b128 v[160:163], v56 offset:0
    ds_read_b64_tr_b16 v[164:165], v64 offset:0
    ds_read_b64_tr_b16 v[166:167], v64 offset:512
    ds_read_b64_tr_b16 v[168:169], v64 offset:8192
    ds_read_b64_tr_b16 v[170:171], v64 offset:8704
    s_waitcnt lgkmcnt(2)
    v_mfma_f32_32x32x16_bf16 v[96:111], v[164:167], v[160:163], 0
    s_add_u32 m0, s63, 65536
    s_mul_i32 s59, s58, 1536
    buffer_load_dwordx4 v4, s[8:11], s58 offen nt lds
    ds_read_b64_tr_b16 v[172:173], v64 offset:16384
    ds_read_b64_tr_b16 v[174:175], v64 offset:16896
    s_waitcnt lgkmcnt(2)
    v_mfma_f32_32x32x16_bf16 v[112:127], v[168:171], v[160:163], 0
    buffer_load_dwordx4 v253, s[8:11], s58 offen offset:1024 nt lds
    ds_read_b128 v[176:179], v57 offset:0
    ds_read_b64_tr_b16 v[180:181], v64 offset:2048
    ds_read_b64_tr_b16 v[182:183], v64 offset:2560
    s_waitcnt lgkmcnt(3)
    v_mfma_f32_32x32x16_bf16 v[128:143], v[172:175], v[160:163], 0
    s_add_u32 m0, s63, 73728
    s_add_u32 s58, s58, 128
    buffer_load_dwordx4 v3, s[12:15], s59 offen lds
    ds_read_b64_tr_b16 v[184:185], v64 offset:10240
    ds_read_b64_tr_b16 v[186:187], v64 offset:10752
    s_waitcnt lgkmcnt(2)
    v_mfma_f32_32x32x16_bf16 v[96:111], v[180:183], v[176:179], v[96:111]
    buffer_load_dwordx4 v252, s[12:15], s59 offen offset:1024 lds
    ds_read_b64_tr_b16 v[188:189], v64 offset:18432
    ds_read_b64_tr_b16 v[190:191], v64 offset:18944
    s_waitcnt lgkmcnt(2)
    v_mfma_f32_32x32x16_bf16 v[112:127], v[184:187], v[176:179], v[112:127]
    s_add_u32 m0, s63, 81920
    s_add_u32 s59, s59, 1024
    buffer_load_dwordx4 v3, s[12:15], s59 offen lds
    ds_read_b128 v[192:195], v58 offset:0
    ds_read_b64_tr_b16 v[196:197], v64 offset:4096
    ds_read_b64_tr_b16 v[198:199], v64 offset:4608
    s_waitcnt lgkmcnt(3)
    v_mfma_f32_32x32x16_bf16 v[128:143], v[188:191], v[176:179], v[128:143]
    buffer_load_dwordx4 v252, s[12:15], s59 offen offset:1024 lds
    ds_read_b64_tr_b16 v[200:201], v64 offset:12288
    ds_read_b64_tr_b16 v[202:203], v64 offset:12800
    s_waitcnt lgkmcnt(2)
    v_mfma_f32_32x32x16_bf16 v[96:111], v[196:199], v[192:195], v[96:111]
    s_add_u32 m0, s63, 90112
    s_add_u32 s59, s59, 1024
    buffer_load_dwordx4 v3, s[12:15], s59 offen lds
    ds_read_b64_tr_b16 v[204:205], v64 offset:20480
    ds_read_b64_tr_b16 v[206:207], v64 offset:20992
    s_waitcnt lgkmcnt(2)
    v_mfma_f32_32x32x16_bf16 v[112:127], v[200:203], v[192:195], v[112:127]
    buffer_load_dwordx4 v252, s[12:15], s59 offen offset:1024 lds
    s_and_b32 s58, s58, 1023
    ds_read_b128 v[160:163], v59 offset:0
    ds_read_b64_tr_b16 v[164:165], v64 offset:6144
    ds_read_b64_tr_b16 v[166:167], v64 offset:6656
    s_waitcnt lgkmcnt(3)
    v_mfma_f32_32x32x16_bf16 v[128:143], v[204:207], v[192:195], v[128:143]
    ds_read_b64_tr_b16 v[168:169], v64 offset:14336
    ds_read_b64_tr_b16 v[170:171], v64 offset:14848
    s_waitcnt lgkmcnt(2)
    v_mfma_f32_32x32x16_bf16 v[96:111], v[164:167], v[160:163], v[96:111]
    ds_read_b64_tr_b16 v[172:173], v64 offset:22528
    ds_read_b64_tr_b16 v[174:175], v64 offset:23040
    s_waitcnt lgkmcnt(2)
    v_mfma_f32_32x32x16_bf16 v[112:127], v[168:171], v[160:163], v[112:127]
    s_waitcnt lgkmcnt(0)
    v_mfma_f32_32x32x16_bf16 v[128:143], v[172:175], v[160:163], v[128:143]
    s_setprio 2
    s_waitcnt vmcnt(8) lgkmcnt(0)
    s_barrier
    s_setprio 0
    ds_read_b128 v[160:163], v56 offset:32768
    ds_read_b64_tr_b16 v[164:165], v64 offset:32768
    ds_read_b64_tr_b16 v[166:167], v64 offset:33280
    ds_read_b64_tr_b16 v[168:169], v64 offset:40960
    ds_read_b64_tr_b16 v[170:171], v64 offset:41472
    s_waitcnt lgkmcnt(2)
    v_mfma_f32_32x32x16_bf16 v[96:111], v[164:167], v[160:163], v[96:111]
    s_add_u32 m0, s61, 147456
    s_and_b32 s60, s60, 0x1ffff
    buffer_load_dwordx4 v1, s[40:43], s60 offen sc1 lds
    ds_read_b64_tr_b16 v[172:173], v64 offset:49152
    ds_read_b64_tr_b16 v[174:175], v64 offset:49664
    s_waitcnt lgkmcnt(2)
    v_mfma_f32_32x32x16_bf16 v[112:127], v[168:171], v[160:163], v[112:127]
    buffer_load_dwordx4 v1, s[40:43], s60 offen offset:1024 sc1 lds
    ds_read_b128 v[176:179], v57 offset:32768
    ds_read_b64_tr_b16 v[180:181], v64 offset:34816
    ds_read_b64_tr_b16 v[182:183], v64 offset:35328
    s_waitcnt lgkmcnt(3)
    v_mfma_f32_32x32x16_bf16 v[128:143], v[172:175], v[160:163], v[128:143]
    buffer_load_dwordx4 v1, s[40:43], s60 offen offset:2048 sc1 lds
    ds_read_b64_tr_b16 v[184:185], v64 offset:43008
    ds_read_b64_tr_b16 v[186:187], v64 offset:43520
    s_waitcnt lgkmcnt(2)
    v_mfma_f32_32x32x16_bf16 v[96:111], v[180:183], v[176:179], v[96:111]
    buffer_load_dwordx4 v1, s[40:43], s60 offen offset:3072 sc1 lds
    ds_read_b64_tr_b16 v[188:189], v64 offset:51200
    ds_read_b64_tr_b16 v[190:191], v64 offset:51712
    s_waitcnt lgkmcnt(2)
    v_mfma_f32_32x32x16_bf16 v[112:127], v[184:187], v[176:179], v[112:127]
    s_add_u32 s60, s60, 16384
    s_add_u32 m0, s63, 98304
    s_mul_i32 s59, s58, 1536
    buffer_load_dwordx4 v4, s[8:11], s58 offen nt lds
    ds_read_b128 v[192:195], v58 offset:32768
    ds_read_b64_tr_b16 v[196:197], v64 offset:36864
    ds_read_b64_tr_b16 v[198:199], v64 offset:37376
    s_waitcnt lgkmcnt(3)
    v_mfma_f32_32x32x16_bf16 v[128:143], v[188:191], v[176:179], v[128:143]
    buffer_load_dwordx4 v253, s[8:11], s58 offen offset:1024 nt lds
    ds_read_b64_tr_b16 v[200:201], v64 offset:45056
    ds_read_b64_tr_b16 v[202:203], v64 offset:45568
    s_waitcnt lgkmcnt(2)
    v_mfma_f32_32x32x16_bf16 v[96:111], v[196:199], v[192:195], v[96:111]
    s_add_u32 m0, s63, 106496
    s_add_u32 s58, s58, 128
    buffer_load_dwordx4 v3, s[12:15], s59 offen lds
    ds_read_b64_tr_b16 v[204:205], v64 offset:53248
    ds_read_b64_tr_b16 v[206:207], v64 offset:53760
    s_waitcnt lgkmcnt(2)
    v_mfma_f32_32x32x16_bf16 v[112:127], v[200:203], v[192:195], v[112:127]
    buffer_load_dwordx4 v252, s[12:15], s59 offen offset:1024 lds
    ds_read_b128 v[160:163], v59 offset:32768
    ds_read_b64_tr_b16 v[164:165], v64 offset:38912
    ds_read_b64_tr_b16 v[166:167], v64 offset:39424
    s_waitcnt lgkmcnt(3)
    v_mfma_f32_32x32x16_bf16 v[128:143], v[204:207], v[192:195], v[128:143]
    s_add_u32 m0, s63, 114688
    s_add_u32 s59, s59, 1024
    buffer_load_dwordx4 v3, s[12:15], s59 offen lds
    ds_read_b64_tr_b16 v[168:169], v64 offset:47104
    ds_read_b64_tr_b16 v[170:171], v64 offset:47616
    s_waitcnt lgkmcnt(2)
    v_mfma_f32_32x32x16_bf16 v[96:111], v[164:167], v[160:163], v[96:111]
    buffer_load_dwordx4 v252, s[12:15], s59 offen offset:1024 lds
    ds_read_b64_tr_b16 v[172:173], v64 offset:55296
    ds_read_b64_tr_b16 v[174:175], v64 offset:55808
    s_waitcnt lgkmcnt(2)
    v_mfma_f32_32x32x16_bf16 v[112:127], v[168:171], v[160:163], v[112:127]
    s_add_u32 m0, s63, 122880
    s_add_u32 s59, s59, 1024
    buffer_load_dwordx4 v3, s[12:15], s59 offen lds
    s_waitcnt lgkmcnt(0)
    v_mfma_f32_32x32x16_bf16 v[128:143], v[172:175], v[160:163], v[128:143]
    buffer_load_dwordx4 v252, s[12:15], s59 offen offset:1024 lds
    s_and_b32 s58, s58, 1023
    s_setprio 2
    s_waitcnt vmcnt(12) lgkmcnt(0)
    s_barrier
    s_cmp_lg_u32 s48, 0
    s_cbranch_scc1 L_np3
    global_load_dwordx2 v[90:91], v246, s[44:45] sc1
    buffer_load_dwordx2 v[82:83], v237, s[40:43], 0 offen sc1
    buffer_load_dwordx2 v[84:85], v237, s[40:43], s64 offen sc1
    buffer_load_dwordx2 v[86:87], v237, s[40:43], s65 offen sc1
    buffer_load_dwordx2 v[88:89], v237, s[40:43], s55 offen sc1
L_np3:
    s_setprio 0
    ds_read_b128 v[160:163], v60 offset:0
    ds_read_b64_tr_b16 v[164:165], v65 offset:0
    ds_read_b64_tr_b16 v[166:167], v65 offset:512
    ds_read_b64_tr_b16 v[168:169], v65 offset:8192
    ds_read_b64_tr_b16 v[170:171], v65 offset:8704
    s_waitcnt lgkmcnt(2)
    v_mfma_f32_32x32x16_bf16 v[96:111], v[164:167], v[160:163], v[96:111]
    s_add_u32 m0, s63, 0
    s_mul_i32 s59, s58, 1536
    buffer_load_dwordx4 v4, s[8:11], s58 offen nt lds
    ds_read_b64_tr_b16 v[172:173], v65 offset:16384
    ds_read_b64_tr_b16 v[174:175], v65 offset:16896
    s_waitcnt lgkmcnt(2)
    v_mfma_f32_32x32x16_bf16 v[112:127], v[168:171], v[160:163], v[112:127]
    buffer_load_dwordx4 v253, s[8:11], s58 offen offset:1024 nt lds
    ds_read_b128 v[176:179], v61 offset:0
    ds_read_b64_tr_b16 v[180:181], v65 offset:2048
    ds_read_b64_tr_b16 v[182:183], v65 offset:2560
    s_waitcnt lgkmcnt(3)
    v_mfma_f32_32x32x16_bf16 v[128:143], v[172:175], v[160:163], v[128:143]
    s_add_u32 m0, s63, 8192
    s_add_u32 s58, s58, 128
    buffer_load_dwordx4 v3, s[12:15], s59 offen lds
    ds_read_b64_tr_b16 v[184:185], v65 offset:10240
    ds_read_b64_tr_b16 v[186:187], v65 offset:10752
    s_waitcnt lgkmcnt(2)
    v_mfma_f32_32x32x16_bf16 v[96:111], v[180:183], v[176:179], v[96:111]
    buffer_load_dwordx4 v252, s[12:15], s59 offen offset:1024 lds
    ds_read_b64_tr_b16 v[188:189], v65 offset:18432
    ds_read_b64_tr_b16 v[190:191], v65 offset:18944
    s_waitcnt lgkmcnt(2)
    v_mfma_f32_32x32x16_bf16 v[112:127], v[184:187], v[176:179], v[112:127]
    s_add_u32 m0, s63, 16384
    s_add_u32 s59, s59, 1024
    buffer_load_dwordx4 v3, s[12:15], s59 offen lds
    ds_read_b128 v[192:195], v62 offset:0
    ds_read_b64_tr_b16 v[196:197], v65 offset:4096
    ds_read_b64_tr_b16 v[198:199], v65 offset:4608
    s_waitcnt lgkmcnt(3)
    v_mfma_f32_32x32x16_bf16 v[128:143], v[188:191], v[176:179], v[128:143]
    buffer_load_dwordx4 v252, s[12:15], s59 offen offset:1024 lds
    ds_read_b64_tr_b16 v[200:201], v65 offset:12288
    ds_read_b64_tr_b16 v[202:203], v65 offset:12800
    s_waitcnt lgkmcnt(2)
    v_mfma_f32_32x32x16_bf16 v[96:111], v[196:199], v[192:195], v[96:111]
    s_add_u32 m0, s63, 24576
    s_add_u32 s59, s59, 1024
    buffer_load_dwordx4 v3, s[12:15], s59 offen lds
    ds_read_b64_tr_b16 v[204:205], v65 offset:20480
    ds_read_b64_tr_b16 v[206:207], v65 offset:20992
    s_waitcnt lgkmcnt(2)
    v_mfma_f32_32x32x16_bf16 v[112:127], v[200:203], v[192:195], v[112:127]
    buffer_load_dwordx4 v252, s[12:15], s59 offen offset:1024 lds
    s_and_b32 s58, s58, 1023
    ds_read_b128 v[160:163], v63 offset:0
    ds_read_b64_tr_b16 v[164:165], v65 offset:6144
    ds_read_b64_tr_b16 v[166:167], v65 offset:6656
    s_waitcnt lgkmcnt(3)
    v_mfma_f32_32x32x16_bf16 v[128:143], v[204:207], v[192:195], v[128:143]
    ds_read_b64_tr_b16 v[168:169], v65 offset:14336
    ds_read_b64_tr_b16 v[170:171], v65 offset:14848
    s_waitcnt lgkmcnt(2)
    v_mfma_f32_32x32x16_bf16 v[96:111], v[164:167], v[160:163], v[96:111]
    ds_read_b64_tr_b16 v[172:173], v65 offset:22528
    ds_read_b64_tr_b16 v[174:175], v65 offset:23040
    s_waitcnt lgkmcnt(2)
    v_mfma_f32_32x32x16_bf16 v[112:127], v[168:171], v[160:163], v[112:127]
    s_waitcnt lgkmcnt(0)
    v_mfma_f32_32x32x16_bf16 v[128:143], v[172:175], v[160:163], v[128:143]
    s_setprio 2
    s_waitcnt vmcnt(8) lgkmcnt(0)
    s_cmp_lg_u32 s48, 0
    s_cbranch_scc1 L_nochk_kv2
    s_mov_b32 s69, 200000
    s_waitcnt vmcnt(8)
    s_branch L_chk_kv2
L_rep_kv2:
    global_load_dwordx2 v[90:91], v246, s[44:45] sc1
    buffer_load_dwordx2 v[82:83], v237, s[40:43], 0 offen sc1
    buffer_load_dwordx2 v[84:85], v237, s[40:43], s64 offen sc1
    buffer_load_dwordx2 v[86:87], v237, s[40:43], s65 offen sc1
    buffer_load_dwordx2 v[88:89], v237, s[40:43], s55 offen sc1
    s_waitcnt vmcnt(0)
L_chk_kv2:
    v_cmp_eq_u32 vcc, 0, v90
    v_cmp_ne_u64 s[46:47], v[90:91], v[82:83]
    s_nop 1
    s_or_b64 vcc, vcc, s[46:47]
    v_cmp_ne_u64 s[46:47], v[90:91], v[84:85]
    s_nop 1
    s_or_b64 vcc, vcc, s[46:47]
    v_cmp_ne_u64 s[46:47], v[90:91], v[86:87]
    s_nop 1
    s_or_b64 vcc, vcc, s[46:47]
    v_cmp_ne_u64 s[46:47], v[90:91], v[88:89]
    s_nop 1
    s_or_b64 vcc, vcc, s[46:47]
    s_cbranch_scc0 L_nochk_kv2
    s_sub_u32 s69, s69, 1
    s_cbranch_scc0 L_rep_kv2
L_nochk_kv2:
    s_barrier
    s_setprio 0
    ds_read_b128 v[160:163], v60 offset:32768
    ds_read_b64_tr_b16 v[164:165], v65 offset:32768
    ds_read_b64_tr_b16 v[166:167], v65 offset:33280
    ds_read_b64_tr_b16 v[168:169], v65 offset:40960
    ds_read_b64_tr_b16 v[170:171], v65 offset:41472
    s_waitcnt lgkmcnt(2)
    v_mfma_f32_32x32x16_bf16 v[96:111], v[164:167], v[160:163], v[96:111]
    s_add_u32 m0, s61, 131072
    s_and_b32 s60, s60, 0x1ffff
    buffer_load_dwordx4 v1, s[40:43], s60 offen sc1 lds
    ds_read_b64_tr_b16 v[172:173], v65 offset:49152
    ds_read_b64_tr_b16 v[174:175], v65 offset:49664
    s_waitcnt lgkmcnt(2)
    v_mfma_f32_32x32x16_bf16 v[112:127], v[168:171], v[160:163], v[112:127]
    buffer_load_dwordx4 v1, s[40:43], s60 offen offset:1024 sc1 lds
    ds_read_b128 v[176:179], v61 offset:32768
    ds_read_b64_tr_b16 v[180:181], v65 offset:34816
    ds_read_b64_tr_b16 v[182:183], v65 offset:35328
    s_waitcnt lgkmcnt(3)
    v_mfma_f32_32x32x16_bf16 v[128:143], v[172:175], v[160:163], v[128:143]
    buffer_load_dwordx4 v1, s[40:43], s60 offen offset:2048 sc1 lds
    ds_read_b64_tr_b16 v[184:185], v65 offset:43008
    ds_read_b64_tr_b16 v[186:187], v65 offset:43520
    s_waitcnt lgkmcnt(2)
    v_mfma_f32_32x32x16_bf16 v[96:111], v[180:183], v[176:179], v[96:111]
    buffer_load_dwordx4 v1, s[40:43], s60 offen offset:3072 sc1 lds
    ds_read_b64_tr_b16 v[188:189], v65 offset:51200
    ds_read_b64_tr_b16 v[190:191], v65 offset:51712
    s_waitcnt lgkmcnt(2)
    v_mfma_f32_32x32x16_bf16 v[112:127], v[184:187], v[176:179], v[112:127]
    s_add_u32 s60, s60, 16384
    s_add_u32 m0, s63, 32768
    s_mul_i32 s59, s58, 1536
    buffer_load_dwordx4 v4, s[8:11], s58 offen nt lds
    ds_read_b128 v[192:195], v62 offset:32768
    ds_read_b64_tr_b16 v[196:197], v65 offset:36864
    ds_read_b64_tr_b16 v[198:199], v65 offset:37376
    s_waitcnt lgkmcnt(3)
    v_mfma_f32_32x32x16_bf16 v[128:143], v[188:191], v[176:179], v[128:143]
    buffer_load_dwordx4 v253, s[8:11], s58 offen offset:1024 nt lds
    ds_read_b64_tr_b16 v[200:201], v65 offset:45056
    ds_read_b64_tr_b16 v[202:203], v65 offset:45568
    s_waitcnt lgkmcnt(2)
    v_mfma_f32_32x32x16_bf16 v[96:111], v[196:199], v[192:195], v[96:111]
    s_add_u32 m0, s63, 40960
    s_add_u32 s58, s58, 128
    buffer_load_dwordx4 v3, s[12:15], s59 offen lds
    ds_read_b64_tr_b16 v[204:205], v65 offset:53248
    ds_read_b64_tr_b16 v[206:207], v65 offset:53760
    s_waitcnt lgkmcnt(2)
    v_mfma_f32_32x32x16_bf16 v[112:127], v[200:203], v[192:195], v[112:127]
    buffer_load_dwordx4 v252, s[12:15], s59 offen offset:1024 lds
    ds_read_b128 v[160:163], v63 offset:32768
    ds_read_b64_tr_b16 v[164:165], v65 offset:38912
    ds_read_b64_tr_b16 v[166:167], v65 offset:39424
    s_waitcnt lgkmcnt(3)
    v_mfma_f32_32x32x16_bf16 v[128:143], v[204:207], v[192:195], v[128:143]
    s_add_u32 m0, s63, 49152
    s_add_u32 s59, s59, 1024
    buffer_load_dwordx4 v3, s[12:15], s59 offen lds
    ds_read_b64_tr_b16 v[168:169], v65 offset:47104
    ds_read_b64_tr_b16 v[170:171], v65 offset:47616
    s_waitcnt lgkmcnt(2)
    v_mfma_f32_32x32x16_bf16 v[96:111], v[164:167], v[160:163], v[96:111]
    buffer_load_dwordx4 v252, s[12:15], s59 offen offset:1024 lds
    ds_read_b64_tr_b16 v[172:173], v65 offset:55296
    ds_read_b64_tr_b16 v[174:175], v65 offset:55808
    s_waitcnt lgkmcnt(2)
    v_mfma_f32_32x32x16_bf16 v[112:127], v[168:171], v[160:163], v[112:127]
    s_add_u32 m0, s63, 57344
    s_add_u32 s59, s59, 1024
    buffer_load_dwordx4 v3, s[12:15], s59 offen lds
    s_waitcnt lgkmcnt(0)
    v_mfma_f32_32x32x16_bf16 v[128:143], v[172:175], v[160:163], v[128:143]
    buffer_load_dwordx4 v252, s[12:15], s59 offen offset:1024 lds
    s_and_b32 s58, s58, 1023
    s_setprio 2
    s_waitcnt vmcnt(12) lgkmcnt(0)
    s_barrier
    s_setprio 0
    ds_read_b128 v[160:163], v56 offset:0
    ds_read_b64_tr_b16 v[164:165], v64 offset:0
    ds_read_b64_tr_b16 v[166:167], v64 offset:512
    ds_read_b64_tr_b16 v[168:169], v64 offset:8192
    ds_read_b64_tr_b16 v[170:171], v64 offset:8704
    s_waitcnt lgkmcnt(2)
    v_mfma_f32_32x32x16_bf16 v[96:111], v[164:167], v[160:163], v[96:111]
    s_add_u32 m0, s63, 65536
    s_mul_i32 s59, s58, 1536
    buffer_load_dwordx4 v4, s[8:11], s58 offen nt lds
    ds_read_b64_tr_b16 v[172:173], v64 offset:16384
    ds_read_b64_tr_b16 v[174:175], v64 offset:16896
    s_waitcnt lgkmcnt(2)
    v_mfma_f32_32x32x16_bf16 v[112:127], v[168:171], v[160:163], v[112:127]
    buffer_load_dwordx4 v253, s[8:11], s58 offen offset:1024 nt lds
    ds_read_b128 v[176:179], v57 offset:0
    ds_read_b64_tr_b16 v[180:181], v64 offset:2048
    ds_read_b64_tr_b16 v[182:183], v64 offset:2560
    s_waitcnt lgkmcnt(3)
    v_mfma_f32_32x32x16_bf16 v[128:143], v[172:175], v[160:163], v[128:143]
    s_add_u32 m0, s63, 73728
    s_add_u32 s58, s58, 128
    buffer_load_dwordx4 v3, s[12:15], s59 offen lds
    ds_read_b64_tr_b16 v[184:185], v64 offset:10240
    ds_read_b64_tr_b16 v[186:187], v64 offset:10752
    s_waitcnt lgkmcnt(2)
    v_mfma_f32_32x32x16_bf16 v[96:111], v[180:183], v[176:179], v[96:111]
    buffer_load_dwordx4 v252, s[12:15], s59 offen offset:1024 lds
    ds_read_b64_tr_b16 v[188:189], v64 offset:18432
    ds_read_b64_tr_b16 v[190:191], v64 offset:18944
    s_waitcnt lgkmcnt(2)
    v_mfma_f32_32x32x16_bf16 v[112:127], v[184:187], v[176:179], v[112:127]
    s_add_u32 m0, s63, 81920
    s_add_u32 s59, s59, 1024
    buffer_load_dwordx4 v3, s[12:15], s59 offen lds
    ds_read_b128 v[192:195], v58 offset:0
    ds_read_b64_tr_b16 v[196:197], v64 offset:4096
    ds_read_b64_tr_b16 v[198:199], v64 offset:4608
    s_waitcnt lgkmcnt(3)
    v_mfma_f32_32x32x16_bf16 v[128:143], v[188:191], v[176:179], v[128:143]
    buffer_load_dwordx4 v252, s[12:15], s59 offen offset:1024 lds
    ds_read_b64_tr_b16 v[200:201], v64 offset:12288
    ds_read_b64_tr_b16 v[202:203], v64 offset:12800
    s_waitcnt lgkmcnt(2)
    v_mfma_f32_32x32x16_bf16 v[96:111], v[196:199], v[192:195], v[96:111]
    s_add_u32 m0, s63, 90112
    s_add_u32 s59, s59, 1024
    buffer_load_dwordx4 v3, s[12:15], s59 offen lds
    ds_read_b64_tr_b16 v[204:205], v64 offset:20480
    ds_read_b64_tr_b16 v[206:207], v64 offset:20992
    s_waitcnt lgkmcnt(2)
    v_mfma_f32_32x32x16_bf16 v[112:127], v[200:203], v[192:195], v[112:127]
    buffer_load_dwordx4 v252, s[12:15], s59 offen offset:1024 lds
    s_and_b32 s58, s58, 1023
    ds_read_b128 v[160:163], v59 offset:0
    ds_read_b64_tr_b16 v[164:165], v64 offset:6144
    ds_read_b64_tr_b16 v[166:167], v64 offset:6656
    s_waitcnt lgkmcnt(3)
    v_mfma_f32_32x32x16_bf16 v[128:143], v[204:207], v[192:195], v[128:143]
    ds_read_b64_tr_b16 v[168:169], v64 offset:14336
    ds_read_b64_tr_b16 v[170:171], v64 offset:14848
    s_waitcnt lgkmcnt(2)
    v_mfma_f32_32x32x16_bf16 v[96:111], v[164:167], v[160:163], v[96:111]
    ds_read_b64_tr_b16 v[172:173], v64 offset:22528
    ds_read_b64_tr_b16 v[174:175], v64 offset:23040
    s_waitcnt lgkmcnt(2)
    v_mfma_f32_32x32x16_bf16 v[112:127], v[168:171], v[160:163], v[112:127]
    s_waitcnt lgkmcnt(0)
    v_mfma_f32_32x32x16_bf16 v[128:143], v[172:175], v[160:163], v[128:143]
    s_setprio 2
    s_waitcnt vmcnt(8) lgkmcnt(0)
    s_barrier
    s_setprio 0
    ds_read_b128 v[160:163], v56 offset:32768
    ds_read_b64_tr_b16 v[164:165], v64 offset:32768
    ds_read_b64_tr_b16 v[166:167], v64 offset:33280
    ds_read_b64_tr_b16 v[168:169], v64 offset:40960
    ds_read_b64_tr_b16 v[170:171], v64 offset:41472
    s_waitcnt lgkmcnt(2)
    v_mfma_f32_32x32x16_bf16 v[96:111], v[164:167], v[160:163], v[96:111]
    s_add_u32 m0, s61, 147456
    s_and_b32 s60, s60, 0x1ffff
    buffer_load_dwordx4 v1, s[40:43], s60 offen sc1 lds
    ds_read_b64_tr_b16 v[172:173], v64 offset:49152
    ds_read_b64_tr_b16 v[174:175], v64 offset:49664
    s_waitcnt lgkmcnt(2)
    v_mfma_f32_32x32x16_bf16 v[112:127], v[168:171], v[160:163], v[112:127]
    buffer_load_dwordx4 v1, s[40:43], s60 offen offset:1024 sc1 lds
    ds_read_b128 v[176:179], v57 offset:32768
    ds_read_b64_tr_b16 v[180:181], v64 offset:34816
    ds_read_b64_tr_b16 v[182:183], v64 offset:35328
    s_waitcnt lgkmcnt(3)
    v_mfma_f32_32x32x16_bf16 v[128:143], v[172:175], v[160:163], v[128:143]
    buffer_load_dwordx4 v1, s[40:43], s60 offen offset:2048 sc1 lds
    ds_read_b64_tr_b16 v[184:185], v64 offset:43008
    ds_read_b64_tr_b16 v[186:187], v64 offset:43520
    s_waitcnt lgkmcnt(2)
    v_mfma_f32_32x32x16_bf16 v[96:111], v[180:183], v[176:179], v[96:111]
    buffer_load_dwordx4 v1, s[40:43], s60 offen offset:3072 sc1 lds
    ds_read_b64_tr_b16 v[188:189], v64 offset:51200
    ds_read_b64_tr_b16 v[190:191], v64 offset:51712
    s_waitcnt lgkmcnt(2)
    v_mfma_f32_32x32x16_bf16 v[112:127], v[184:187], v[176:179], v[112:127]
    s_add_u32 s60, s60, 16384
    s_add_u32 m0, s63, 98304
    s_mul_i32 s59, s58, 1536
    buffer_load_dwordx4 v4, s[8:11], s58 offen nt lds
    ds_read_b128 v[192:195], v58 offset:32768
    ds_read_b64_tr_b16 v[196:197], v64 offset:36864
    ds_read_b64_tr_b16 v[198:199], v64 offset:37376
    s_waitcnt lgkmcnt(3)
    v_mfma_f32_32x32x16_bf16 v[128:143], v[188:191], v[176:179], v[128:143]
    buffer_load_dwordx4 v253, s[8:11], s58 offen offset:1024 nt lds
    ds_read_b64_tr_b16 v[200:201], v64 offset:45056
    ds_read_b64_tr_b16 v[202:203], v64 offset:45568
    s_waitcnt lgkmcnt(2)
    v_mfma_f32_32x32x16_bf16 v[96:111], v[196:199], v[192:195], v[96:111]
    s_add_u32 m0, s63, 106496
    s_add_u32 s58, s58, 128
    buffer_load_dwordx4 v3, s[12:15], s59 offen lds
    ds_read_b64_tr_b16 v[204:205], v64 offset:53248
    ds_read_b64_tr_b16 v[206:207], v64 offset:53760
    s_waitcnt lgkmcnt(2)
    v_mfma_f32_32x32x16_bf16 v[112:127], v[200:203], v[192:195], v[112:127]
    buffer_load_dwordx4 v252, s[12:15], s59 offen offset:1024 lds
    ds_read_b128 v[160:163], v59 offset:32768
    ds_read_b64_tr_b16 v[164:165], v64 offset:38912
    ds_read_b64_tr_b16 v[166:167], v64 offset:39424
    s_waitcnt lgkmcnt(3)
    v_mfma_f32_32x32x16_bf16 v[128:143], v[204:207], v[192:195], v[128:143]
    s_add_u32 m0, s63, 114688
    s_add_u32 s59, s59, 1024
    buffer_load_dwordx4 v3, s[12:15], s59 offen lds
    ds_read_b64_tr_b16 v[168:169], v64 offset:47104
    ds_read_b64_tr_b16 v[170:171], v64 offset:47616
    s_waitcnt lgkmcnt(2)
    v_mfma_f32_32x32x16_bf16 v[96:111], v[164:167], v[160:163], v[96:111]
    buffer_load_dwordx4 v252, s[12:15], s59 offen offset:1024 lds
    ds_read_b64_tr_b16 v[172:173], v64 offset:55296
    ds_read_b64_tr_b16 v[174:175], v64 offset:55808
    s_waitcnt lgkmcnt(2)
    v_mfma_f32_32x32x16_bf16 v[112:127], v[168:171], v[160:163], v[112:127]
    s_add_u32 m0, s63, 122880
    s_add_u32 s59, s59, 1024
    buffer_load_dwordx4 v3, s[12:15], s59 offen lds
    s_waitcnt lgkmcnt(0)
    v_mfma_f32_32x32x16_bf16 v[128:143], v[172:175], v[160:163], v[128:143]
    buffer_load_dwordx4 v252, s[12:15], s59 offen offset:1024 lds
    s_and_b32 s58, s58, 1023
    s_setprio 2
    s_waitcnt vmcnt(12) lgkmcnt(0)
    s_barrier
    s_setprio 0
    ds_read_b128 v[160:163], v60 offset:0
    ds_read_b64_tr_b16 v[164:165], v65 offset:0
    ds_read_b64_tr_b16 v[166:167], v65 offset:512
    ds_read_b64_tr_b16 v[168:169], v65 offset:8192
    ds_read_b64_tr_b16 v[170:171], v65 offset:8704
    s_waitcnt lgkmcnt(2)
    v_mfma_f32_32x32x16_bf16 v[96:111], v[164:167], v[160:163], v[96:111]
    s_add_u32 s51, s70, 0x200000
    s_add_u32 s52, s51, 32768
    buffer_store_dwordx4 v[248:251], v1, s[40:43], s51 offen sc1
    ds_read_b64_tr_b16 v[172:173], v65 offset:16384
    ds_read_b64_tr_b16 v[174:175], v65 offset:16896
    s_waitcnt lgkmcnt(2)
    v_mfma_f32_32x32x16_bf16 v[112:127], v[168:171], v[160:163], v[112:127]
    buffer_store_dwordx4 v[248:251], v1, s[40:43], s52 offen sc1
    ds_read_b128 v[176:179], v61 offset:0
    ds_read_b64_tr_b16 v[180:181], v65 offset:2048
    ds_read_b64_tr_b16 v[182:183], v65 offset:2560
    s_waitcnt lgkmcnt(3)
    v_mfma_f32_32x32x16_bf16 v[128:143], v[172:175], v[160:163], v[128:143]
    global_load_dwordx2 v[90:91], v246, s[44:45] sc1
    ds_read_b64_tr_b16 v[184:185], v65 offset:10240
    ds_read_b64_tr_b16 v[186:187], v65 offset:10752
    s_waitcnt lgkmcnt(2)
    v_mfma_f32_32x32x16_bf16 v[96:111], v[180:183], v[176:179], v[96:111]
    s_add_u32 s51, s68, 0
    s_add_u32 m0, s63, 0
    s_and_b32 s51, s51, 0x7ffff
    buffer_load_dwordx4 v2, s[16:19], s51 offen lds
    ds_read_b64_tr_b16 v[188:189], v65 offset:18432
    ds_read_b64_tr_b16 v[190:191], v65 offset:18944
    s_waitcnt lgkmcnt(2)
    v_mfma_f32_32x32x16_bf16 v[112:127], v[184:187], v[176:179], v[112:127]
    buffer_load_dwordx4 v239, s[16:19], s51 offen offset:1024 lds
    ds_read_b128 v[192:195], v62 offset:0
    ds_read_b64_tr_b16 v[196:197], v65 offset:4096
    ds_read_b64_tr_b16 v[198:199], v65 offset:4608
    s_waitcnt lgkmcnt(3)
    v_mfma_f32_32x32x16_bf16 v[128:143], v[188:191], v[176:179], v[128:143]
    s_add_u32 s51, s51, 65536
    s_add_u32 m0, s63, 8192
    s_and_b32 s51, s51, 0x7ffff
    buffer_load_dwordx4 v2, s[16:19], s51 offen lds
    ds_read_b64_tr_b16 v[200:201], v65 offset:12288
    ds_read_b64_tr_b16 v[202:203], v65 offset:12800
    s_waitcnt lgkmcnt(2)
    v_mfma_f32_32x32x16_bf16 v[96:111], v[196:199], v[192:195], v[96:111]
    buffer_load_dwordx4 v239, s[16:19], s51 offen offset:1024 lds
    ds_read_b64_tr_b16 v[204:205], v65 offset:20480
    ds_read_b64_tr_b16 v[206:207], v65 offset:20992
    s_waitcnt lgkmcnt(2)
    v_mfma_f32_32x32x16_bf16 v[112:127], v[200:203], v[192:195], v[112:127]
    s_add_u32 s51, s51, 65536
    s_add_u32 m0, s63, 16384
    s_and_b32 s51, s51, 0x7ffff
    buffer_load_dwordx4 v2, s[16:19], s51 offen lds
    ds_read_b128 v[160:163], v63 offset:0
    ds_read_b64_tr_b16 v[164:165], v65 offset:6144
    ds_read_b64_tr_b16 v[166:167], v65 offset:6656
    s_waitcnt lgkmcnt(3)
    v_mfma_f32_32x32x16_bf16 v[128:143], v[204:207], v[192:195], v[128:143]
    buffer_load_dwordx4 v239, s[16:19], s51 offen offset:1024 lds
    ds_read_b64_tr_b16 v[168:169], v65 offset:14336
    ds_read_b64_tr_b16 v[170:171], v65 offset:14848
    s_waitcnt lgkmcnt(2)
    v_mfma_f32_32x32x16_bf16 v[96:111], v[164:167], v[160:163], v[96:111]
    s_add_u32 s51, s51, 65536
    s_add_u32 m0, s63, 24576
    s_and_b32 s51, s51, 0x7ffff
    buffer_load_dwordx4 v2, s[16:19], s51 offen lds
    ds_read_b64_tr_b16 v[172:173], v65 offset:22528
    ds_read_b64_tr_b16 v[174:175], v65 offset:23040
    s_waitcnt lgkmcnt(2)
    v_mfma_f32_32x32x16_bf16 v[112:127], v[168:171], v[160:163], v[112:127]
    buffer_load_dwordx4 v239, s[16:19], s51 offen offset:1024 lds
    s_waitcnt lgkmcnt(0)
    v_mfma_f32_32x32x16_bf16 v[128:143], v[172:175], v[160:163], v[128:143]
    s_setprio 2
    s_waitcnt vmcnt(11) lgkmcnt(0)
    s_barrier
    s_setprio 0
    ds_read_b128 v[160:163], v60 offset:32768
    ds_read_b64_tr_b16 v[164:165], v65 offset:32768
    ds_read_b64_tr_b16 v[166:167], v65 offset:33280
    ds_read_b64_tr_b16 v[168:169], v65 offset:40960
    ds_read_b64_tr_b16 v[170:171], v65 offset:41472
    s_waitcnt lgkmcnt(2)
    v_mfma_f32_32x32x16_bf16 v[96:111], v[164:167], v[160:163], v[96:111]
    s_add_u32 m0, s61, 131072
    s_and_b32 s60, s60, 0x1ffff
    buffer_load_dwordx4 v1, s[40:43], s60 offen sc1 lds
    ds_read_b64_tr_b16 v[172:173], v65 offset:49152
    ds_read_b64_tr_b16 v[174:175], v65 offset:49664
    s_waitcnt lgkmcnt(2)
    v_mfma_f32_32x32x16_bf16 v[112:127], v[168:171], v[160:163], v[112:127]
    buffer_load_dwordx4 v1, s[40:43], s60 offen offset:1024 sc1 lds
    ds_read_b128 v[176:179], v61 offset:32768
    ds_read_b64_tr_b16 v[180:181], v65 offset:34816
    ds_read_b64_tr_b16 v[182:183], v65 offset:35328
    s_waitcnt lgkmcnt(3)
    v_mfma_f32_32x32x16_bf16 v[128:143], v[172:175], v[160:163], v[128:143]
    buffer_load_dwordx4 v1, s[40:43], s60 offen offset:2048 sc1 lds
    ds_read_b64_tr_b16 v[184:185], v65 offset:43008
    ds_read_b64_tr_b16 v[186:187], v65 offset:43520
    s_waitcnt lgkmcnt(2)
    v_mfma_f32_32x32x16_bf16 v[96:111], v[180:183], v[176:179], v[96:111]
    buffer_load_dwordx4 v1, s[40:43], s60 offen offset:3072 sc1 lds
    s_add_u32 s60, s60, 16384
    ds_read_b64_tr_b16 v[188:189], v65 offset:51200
    ds_read_b64_tr_b16 v[190:191], v65 offset:51712
    s_waitcnt lgkmcnt(2)
    v_mfma_f32_32x32x16_bf16 v[112:127], v[184:187], v[176:179], v[112:127]
    ds_read_b128 v[192:195], v62 offset:32768
    ds_read_b64_tr_b16 v[196:197], v65 offset:36864
    ds_read_b64_tr_b16 v[198:199], v65 offset:37376
    s_waitcnt lgkmcnt(3)
    v_mfma_f32_32x32x16_bf16 v[128:143], v[188:191], v[176:179], v[128:143]
    ds_read_b64_tr_b16 v[200:201], v65 offset:45056
    ds_read_b64_tr_b16 v[202:203], v65 offset:45568
    s_waitcnt lgkmcnt(2)
    v_mfma_f32_32x32x16_bf16 v[96:111], v[196:199], v[192:195], v[96:111]
    ds_read_b64_tr_b16 v[204:205], v65 offset:53248
    ds_read_b64_tr_b16 v[206:207], v65 offset:53760
    s_waitcnt lgkmcnt(2)
    v_mfma_f32_32x32x16_bf16 v[112:127], v[200:203], v[192:195], v[112:127]
    ds_read_b128 v[160:163], v63 offset:32768
    ds_read_b64_tr_b16 v[164:165], v65 offset:38912
    ds_read_b64_tr_b16 v[166:167], v65 offset:39424
    s_waitcnt lgkmcnt(3)
    v_mfma_f32_32x32x16_bf16 v[128:143], v[204:207], v[192:195], v[128:143]
    ds_read_b64_tr_b16 v[168:169], v65 offset:47104
    ds_read_b64_tr_b16 v[170:171], v65 offset:47616
    s_waitcnt lgkmcnt(2)
    v_mfma_f32_32x32x16_bf16 v[96:111], v[164:167], v[160:163], v[96:111]
    ds_read_b64_tr_b16 v[172:173], v65 offset:55296
    ds_read_b64_tr_b16 v[174:175], v65 offset:55808
    s_waitcnt lgkmcnt(2)
    v_mfma_f32_32x32x16_bf16 v[112:127], v[168:171], v[160:163], v[112:127]
    s_waitcnt lgkmcnt(0)
    v_mfma_f32_32x32x16_bf16 v[128:143], v[172:175], v[160:163], v[128:143]
    s_setprio 2
    s_nop 6
    v_cvt_pk_bf16_f32 v96, v96, v97
    v_cvt_pk_bf16_f32 v97, v98, v99
    v_cvt_pk_bf16_f32 v98, v100, v101
    v_cvt_pk_bf16_f32 v99, v102, v103
    ds_write_b128 v72, v[96:99] offset:0
    v_cvt_pk_bf16_f32 v104, v104, v105
    v_cvt_pk_bf16_f32 v105, v106, v107
    v_cvt_pk_bf16_f32 v106, v108, v109
    v_cvt_pk_bf16_f32 v107, v110, v111
    ds_write_b128 v72, v[104:107] offset:1024
    v_cvt_pk_bf16_f32 v112, v112, v113
    v_cvt_pk_bf16_f32 v113, v114, v115
    v_cvt_pk_bf16_f32 v114, v116, v117
    v_cvt_pk_bf16_f32 v115, v118, v119
    ds_write_b128 v72, v[112:115] offset:8192
    v_cvt_pk_bf16_f32 v120, v120, v121
    v_cvt_pk_bf16_f32 v121, v122, v123
    v_cvt_pk_bf16_f32 v122, v124, v125
    v_cvt_pk_bf16_f32 v123, v126, v127
    ds_write_b128 v72, v[120:123] offset:9216
    v_cvt_pk_bf16_f32 v128, v128, v129
    v_cvt_pk_bf16_f32 v129, v130, v131
    v_cvt_pk_bf16_f32 v130, v132, v133
    v_cvt_pk_bf16_f32 v131, v134, v135
    ds_write_b128 v72, v[128:131] offset:16384
    v_cvt_pk_bf16_f32 v136, v136, v137
    v_cvt_pk_bf16_f32 v137, v138, v139
    v_cvt_pk_bf16_f32 v138, v140, v141
    v_cvt_pk_bf16_f32 v139, v142, v143
    ds_write_b128 v72, v[136:139] offset:17408
    s_bitcmp1_b32 s48, 0
    s_cbranch_scc0 L_nopub
    s_add_u32 s51, s56, 4096
    buffer_store_dwordx4 v[112:115], v1, s[40:43], s56 offen sc1
    buffer_store_dwordx4 v[120:123], v1, s[40:43], s56 offen offset:1024 sc1
    buffer_store_dwordx4 v[128:131], v1, s[40:43], s51 offen sc1
    buffer_store_dwordx4 v[136:139], v1, s[40:43], s51 offen offset:1024 sc1
L_nopub:
    s_waitcnt lgkmcnt(0)
    s_barrier
    ds_write_b64 v247, v[76:77]
    s_bitcmp1_b32 s48, 0
    s_cbranch_scc0 L_nohf
    s_mov_b32 s69, 200000
    s_waitcnt vmcnt(0)
L_fw_hx:
    v_cmp_eq_u32 vcc, 0, v90
    s_cbranch_vccz L_fs_hx
    global_load_dwordx2 v[90:91], v246, s[44:45] sc1
    s_waitcnt vmcnt(0)
    s_sub_u32 s69, s69, 1
    s_cbranch_scc0 L_fw_hx
L_fs_hx:
    s_mov_b64 exec, 1
    buffer_store_dwordx2 v[90:91], v246, s[40:43], s57 offen sc1
    s_mov_b64 exec, -1
L_nohf:
    ds_read_b128 v[160:163], v73 offset:4096
    ds_read_b128 v[164:167], v73 offset:12288
    ds_read_b128 v[168:171], v73 offset:8192
    ds_read_b64_tr_b16 v[172:173], v79
    ds_read_b64_tr_b16 v[174:175], v79 offset:64
    ds_read_b64_tr_b16 v[176:177], v79 offset:256
    ds_read_b64_tr_b16 v[178:179], v79 offset:320
    ds_read_b64_tr_b16 v[180:181], v78 offset:256
    ds_read_b64_tr_b16 v[182:183], v78 offset:320
    s_waitcnt lgkmcnt(6)
    s_nop 0
    v_mfma_f32_32x32x16_bf16 v[96:111], v[164:167], v[160:163], v[32:47]
    v_mfma_f32_32x32x16_bf16 v[112:127], v[168:171], v[160:163], v[40:55]
    s_nop 10
    v_max3_f32 v8, v96, v97, v98
    v_max3_f32 v9, v99, v100, v101
    v_max3_f32 v8, v8, v102, v103
    v_max3_f32 v9, v9, v104, v105
    v_max3_f32 v8, v8, v106, v107
    v_max3_f32 v9, v9, v108, v109
    v_max3_f32 v8, v8, v110, v111
    v_max3_f32 v9, v9, v120, v121
    v_max3_f32 v8, v8, v122, v123
    v_max3_f32 v9, v9, v124, v125
    v_max3_f32 v8, v8, v126, v127
    v_max_f32 v8, v8, v9
    v_mov_b32 v9, v8
    s_nop 1
    v_permlane32_swap_b32 v8, v9
    v_max_f32 v8, v8, v9
    v_mul_f32 v8, 0xbeb8aa3b, v8
    v_pk_fma_f32 v[96:97], v[96:97], s[74:75], v[8:9] op_sel_hi:[1,0,0]
    v_pk_fma_f32 v[98:99], v[98:99], s[74:75], v[8:9] op_sel_hi:[1,0,0]
    v_pk_fma_f32 v[100:101], v[100:101], s[74:75], v[8:9] op_sel_hi:[1,0,0]
    v_pk_fma_f32 v[102:103], v[102:103], s[74:75], v[8:9] op_sel_hi:[1,0,0]
    v_pk_fma_f32 v[104:105], v[104:105], s[74:75], v[8:9] op_sel_hi:[1,0,0]
    v_pk_fma_f32 v[106:107], v[106:107], s[74:75], v[8:9] op_sel_hi:[1,0,0]
    v_pk_fma_f32 v[108:109], v[108:109], s[74:75], v[8:9] op_sel_hi:[1,0,0]
    v_pk_fma_f32 v[110:111], v[110:111], s[74:75], v[8:9] op_sel_hi:[1,0,0]
    v_pk_fma_f32 v[120:121], v[120:121], s[74:75], v[8:9] op_sel_hi:[1,0,0]
    v_pk_fma_f32 v[122:123], v[122:123], s[74:75], v[8:9] op_sel_hi:[1,0,0]
    v_pk_fma_f32 v[124:125], v[124:125], s[74:75], v[8:9] op_sel_hi:[1,0,0]
    v_pk_fma_f32 v[126:127], v[126:127], s[74:75], v[8:9] op_sel_hi:[1,0,0]
    s_waitcnt lgkmcnt(0)
    v_exp_f32 v96, v96
    v_exp_f32 v97, v97
    v_exp_f32 v98, v98
    v_exp_f32 v99, v99
    v_exp_f32 v100, v100
    v_exp_f32 v101, v101
    v_exp_f32 v102, v102
    v_exp_f32 v103, v103
    v_exp_f32 v104, v104
    v_exp_f32 v105, v105
    v_smfmac_f32_32x32x32_bf16 v[16:31], v[172:175], v[96:103], v236
    v_exp_f32 v106, v106
    v_exp_f32 v107, v107
    v_exp_f32 v108, v108
    v_exp_f32 v109, v109
    v_exp_f32 v110, v110
    v_exp_f32 v111, v111
    v_exp_f32 v120, v120
    v_exp_f32 v121, v121
    v_smfmac_f32_32x32x32_bf16 v[16:31], v[176:179], v[104:111], v236
    v_exp_f32 v122, v122
    v_exp_f32 v123, v123
    v_exp_f32 v124, v124
    v_exp_f32 v125, v125
    v_exp_f32 v126, v126
    v_exp_f32 v127, v127
    s_nop 1
    v_smfmac_f32_32x32x32_bf16 v[16:31], v[180:183], v[120:127], v236
    s_nop 11
    v_rcp_f32 v10, v24
    s_nop 0
    v_pk_mul_f32 v[16:17], v[16:17], v[10:11] op_sel_hi:[1,0]
    v_pk_mul_f32 v[18:19], v[18:19], v[10:11] op_sel_hi:[1,0]
    v_pk_mul_f32 v[20:21], v[20:21], v[10:11] op_sel_hi:[1,0]
    v_pk_mul_f32 v[22:23], v[22:23], v[10:11] op_sel_hi:[1,0]
    v_cvt_pk_bf16_f32 v148, v16, v17
    v_cvt_pk_bf16_f32 v149, v18, v19
    v_cvt_pk_bf16_f32 v150, v20, v21
    v_cvt_pk_bf16_f32 v151, v22, v23
    buffer_store_dwordx4 v[148:151], v1, s[40:43], s71 offen sc1
    s_waitcnt vmcnt(1) lgkmcnt(0)
    s_barrier
    s_add_u32 m0, s61, 147456
    s_and_b32 s60, s60, 0x1ffff
    buffer_load_dwordx4 v1, s[40:43], s60 offen sc1 lds
    buffer_load_dwordx4 v1, s[40:43], s60 offen offset:1024 sc1 lds
    buffer_load_dwordx4 v1, s[40:43], s60 offen offset:2048 sc1 lds
    buffer_load_dwordx4 v1, s[40:43], s60 offen offset:3072 sc1 lds
    s_add_u32 s60, s60, 16384
    s_mov_b32 s69, 200000
L_rep_hx:
    global_load_dwordx2 v[90:91], v246, s[44:45] sc1
    buffer_load_dwordx2 v[92:93], v233, s[40:43], 0 offen sc1
    s_waitcnt vmcnt(0)
L_chk_hx:
    v_cmp_eq_u32 vcc, 0, v90
    v_cmp_ne_u64 s[46:47], v[90:91], v[92:93]
    s_nop 1
    s_or_b64 vcc, vcc, s[46:47]
    s_cbranch_scc0 L_nochk_hx
    s_sub_u32 s69, s69, 1
    s_cbranch_scc0 L_rep_hx
L_nochk_hx:
    s_lshl_b32 s51, s48, 10
    s_add_u32 m0, s51, 90112
    s_add_u32 s52, s31, 4096
    buffer_load_dwordx4 v1, s[40:43], s31 offen sc1 lds
    s_add_u32 m0, s51, 94208
    s_nop 0
    buffer_load_dwordx4 v1, s[40:43], s52 offen sc1 lds
    s_add_u32 s51, s68, 262144
    s_add_u32 m0, s63, 32768
    s_and_b32 s51, s51, 0x7ffff
    buffer_load_dwordx4 v2, s[16:19], s51 offen lds
    buffer_load_dwordx4 v239, s[16:19], s51 offen offset:1024 lds
    s_add_u32 s51, s51, 65536
    s_add_u32 m0, s63, 40960
    s_and_b32 s51, s51, 0x7ffff
    buffer_load_dwordx4 v2, s[16:19], s51 offen lds
    buffer_load_dwordx4 v239, s[16:19], s51 offen offset:1024 lds
    s_add_u32 s51, s51, 65536
    s_add_u32 m0, s63, 49152
    s_and_b32 s51, s51, 0x7ffff
    buffer_load_dwordx4 v2, s[16:19], s51 offen lds
    buffer_load_dwordx4 v239, s[16:19], s51 offen offset:1024 lds
    s_add_u32 s51, s51, 65536
    s_add_u32 m0, s63, 57344
    s_and_b32 s51, s51, 0x7ffff
    buffer_load_dwordx4 v2, s[16:19], s51 offen lds
    buffer_load_dwordx4 v239, s[16:19], s51 offen offset:1024 lds
    s_waitcnt lgkmcnt(0)
    s_barrier
    s_waitcnt vmcnt(8)
    ds_read_b128 v[160:163], v73 offset:0
    ds_read_b128 v[164:167], v73 offset:8192
    ds_read_b128 v[168:171], v73 offset:24576
    ds_read_b64_tr_b16 v[172:173], v78
    ds_read_b64_tr_b16 v[174:175], v78 offset:64
    ds_read_b64_tr_b16 v[176:177], v78 offset:256
    ds_read_b64_tr_b16 v[178:179], v78 offset:320
    ds_read_b64_tr_b16 v[180:181], v80 offset:256
    ds_read_b64_tr_b16 v[182:183], v80 offset:320
    s_cmp_lg_u32 s49, 0
    s_cbranch_scc1 L_m0
    v_mov_b32 v48, 0xff800000
    v_mov_b32 v49, 0xff800000
    v_mov_b32 v50, 0xff800000
    v_mov_b32 v51, 0xff800000
    v_mov_b32 v52, 0xff800000
    v_mov_b32 v53, 0xff800000
    v_mov_b32 v54, 0xff800000
    v_mov_b32 v55, 0xff800000
L_m0:
    s_waitcnt lgkmcnt(6)
    s_nop 0
    v_mfma_f32_32x32x16_bf16 v[96:111], v[164:167], v[160:163], v[32:47]
    v_mfma_f32_32x32x16_bf16 v[112:127], v[168:171], v[160:163], v[40:55]
    s_nop 10
    v_max3_f32 v8, v96, v97, v98
    v_max3_f32 v9, v99, v100, v101
    v_max3_f32 v8, v8, v102, v103
    v_max3_f32 v9, v9, v104, v105
    v_max3_f32 v8, v8, v106, v107
    v_max3_f32 v9, v9, v108, v109
    v_max3_f32 v8, v8, v110, v111
    v_max3_f32 v9, v9, v120, v121
    v_max3_f32 v8, v8, v122, v123
    v_max3_f32 v9, v9, v124, v125
    v_max3_f32 v8, v8, v126, v127
    v_max_f32 v8, v8, v9
    v_mov_b32 v9, v8
    s_nop 1
    v_permlane32_swap_b32 v8, v9
    v_max_f32 v8, v8, v9
    v_mul_f32 v8, 0xbeb8aa3b, v8
    v_pk_fma_f32 v[96:97], v[96:97], s[74:75], v[8:9] op_sel_hi:[1,0,0]
    v_pk_fma_f32 v[98:99], v[98:99], s[74:75], v[8:9] op_sel_hi:[1,0,0]
    v_pk_fma_f32 v[100:101], v[100:101], s[74:75], v[8:9] op_sel_hi:[1,0,0]
    v_pk_fma_f32 v[102:103], v[102:103], s[74:75], v[8:9] op_sel_hi:[1,0,0]
    v_pk_fma_f32 v[104:105], v[104:105], s[74:75], v[8:9] op_sel_hi:[1,0,0]
    v_pk_fma_f32 v[106:107], v[106:107], s[74:75], v[8:9] op_sel_hi:[1,0,0]
    v_pk_fma_f32 v[108:109], v[108:109], s[74:75], v[8:9] op_sel_hi:[1,0,0]
    v_pk_fma_f32 v[110:111], v[110:111], s[74:75], v[8:9] op_sel_hi:[1,0,0]
    v_pk_fma_f32 v[120:121], v[120:121], s[74:75], v[8:9] op_sel_hi:[1,0,0]
    v_pk_fma_f32 v[122:123], v[122:123], s[74:75], v[8:9] op_sel_hi:[1,0,0]
    v_pk_fma_f32 v[124:125], v[124:125], s[74:75], v[8:9] op_sel_hi:[1,0,0]
    v_pk_fma_f32 v[126:127], v[126:127], s[74:75], v[8:9] op_sel_hi:[1,0,0]
    s_waitcnt lgkmcnt(0)
    v_exp_f32 v96, v96
    v_exp_f32 v97, v97
    v_exp_f32 v98, v98
    v_exp_f32 v99, v99
    v_exp_f32 v100, v100
    v_exp_f32 v101, v101
    v_exp_f32 v102, v102
    v_exp_f32 v103, v103
    v_exp_f32 v104, v104
    v_exp_f32 v105, v105
    v_smfmac_f32_32x32x32_bf16 v[208:223], v[172:175], v[96:103], v236
    v_exp_f32 v106, v106
    v_exp_f32 v107, v107
    v_exp_f32 v108, v108
    v_exp_f32 v109, v109
    v_exp_f32 v110, v110
    v_exp_f32 v111, v111
    v_exp_f32 v120, v120
    v_exp_f32 v121, v121
    v_smfmac_f32_32x32x32_bf16 v[208:223], v[176:179], v[104:111], v236
    v_exp_f32 v122, v122
    v_exp_f32 v123, v123
    v_exp_f32 v124, v124
    v_exp_f32 v125, v125
    v_exp_f32 v126, v126
    v_exp_f32 v127, v127
    s_nop 1
    v_smfmac_f32_32x32x32_bf16 v[208:223], v[180:183], v[120:127], v236
    s_nop 11
    v_rcp_f32 v10, v216
    s_nop 0
    v_pk_mul_f32 v[208:209], v[208:209], v[10:11] op_sel_hi:[1,0]
    v_pk_mul_f32 v[210:211], v[210:211], v[10:11] op_sel_hi:[1,0]
    v_pk_mul_f32 v[212:213], v[212:213], v[10:11] op_sel_hi:[1,0]
    v_pk_mul_f32 v[214:215], v[214:215], v[10:11] op_sel_hi:[1,0]
    v_cvt_pk_bf16_f32 v144, v208, v209
    v_cvt_pk_bf16_f32 v145, v210, v211
    v_cvt_pk_bf16_f32 v146, v212, v213
    v_cvt_pk_bf16_f32 v147, v214, v215
    buffer_store_dwordx4 v[144:147], v1, s[40:43], s70 offen sc1
    s_waitcnt vmcnt(1) lgkmcnt(0)
    s_barrier
    s_add_u32 m0, s61, 131072
    s_and_b32 s60, s60, 0x1ffff
    buffer_load_dwordx4 v1, s[40:43], s60 offen sc1 lds
    buffer_load_dwordx4 v1, s[40:43], s60 offen offset:1024 sc1 lds
    buffer_load_dwordx4 v1, s[40:43], s60 offen offset:2048 sc1 lds
    buffer_load_dwordx4 v1, s[40:43], s60 offen offset:3072 sc1 lds
    s_add_u32 s60, s60, 16384
    s_add_u32 s51, s68, 0
    s_add_u32 m0, s63, 65536
    s_and_b32 s51, s51, 0x7ffff
    buffer_load_dwordx4 v2, s[32:35], s51 offen lds
    buffer_load_dwordx4 v239, s[32:35], s51 offen offset:1024 lds
    s_add_u32 s51, s51, 65536
    s_add_u32 m0, s63, 73728
    s_and_b32 s51, s51, 0x7ffff
    buffer_load_dwordx4 v2, s[32:35], s51 offen lds
    buffer_load_dwordx4 v239, s[32:35], s51 offen offset:1024 lds
    s_add_u32 s51, s51, 65536
    s_add_u32 m0, s63, 81920
    s_and_b32 s51, s51, 0x7ffff
    buffer_load_dwordx4 v2, s[32:35], s51 offen lds
    buffer_load_dwordx4 v239, s[32:35], s51 offen offset:1024 lds
    s_add_u32 s51, s51, 65536
    s_add_u32 m0, s63, 90112
    s_and_b32 s51, s51, 0x7ffff
    buffer_load_dwordx4 v2, s[32:35], s51 offen lds
    buffer_load_dwordx4 v239, s[32:35], s51 offen offset:1024 lds
    s_mov_b32 s69, 200000
    s_waitcnt vmcnt(12)
L_fw_oa:
    v_cmp_eq_u32 vcc, 0, v90
    s_cbranch_vccz L_fs_oa
    global_load_dwordx2 v[90:91], v246, s[44:45] sc1
    s_waitcnt vmcnt(0)
    s_sub_u32 s69, s69, 1
    s_cbranch_scc0 L_fw_oa
L_fs_oa:
    v_or_b32 v90, s30, v90
    s_mov_b64 exec, 1
    buffer_store_dwordx2 v[90:91], v246, s[40:43], s5 offen sc1
    s_mov_b64 exec, -1
    s_waitcnt lgkmcnt(0)
    s_barrier
    ds_read_b64_tr_b16 v[96:97], v240 offset:0
    ds_read_b64_tr_b16 v[98:99], v240 offset:1024
    ds_read_b64_tr_b16 v[100:101], v241 offset:0
    ds_read_b64_tr_b16 v[102:103], v241 offset:1024
    ds_read_b64_tr_b16 v[104:105], v240 offset:2048
    ds_read_b64_tr_b16 v[106:107], v240 offset:3072
    ds_read_b64_tr_b16 v[108:109], v241 offset:2048
    ds_read_b64_tr_b16 v[110:111], v241 offset:3072
    ds_read_b64_tr_b16 v[112:113], v240 offset:4096
    ds_read_b64_tr_b16 v[114:115], v240 offset:5120
    ds_read_b64_tr_b16 v[116:117], v241 offset:4096
    ds_read_b64_tr_b16 v[118:119], v241 offset:5120
    ds_read_b64_tr_b16 v[120:121], v240 offset:6144
    ds_read_b64_tr_b16 v[122:123], v240 offset:7168
    ds_read_b64_tr_b16 v[124:125], v241 offset:6144
    ds_read_b64_tr_b16 v[126:127], v241 offset:7168
    ds_read_b64_tr_b16 v[128:129], v240 offset:8192
    ds_read_b64_tr_b16 v[130:131], v240 offset:9216
    ds_read_b64_tr_b16 v[132:133], v241 offset:8192
    ds_read_b64_tr_b16 v[134:135], v241 offset:9216
    ds_read_b64_tr_b16 v[136:137], v240 offset:10240
    ds_read_b64_tr_b16 v[138:139], v240 offset:11264
    ds_read_b64_tr_b16 v[140:141], v241 offset:10240
    ds_read_b64_tr_b16 v[142:143], v241 offset:11264
    ds_read_b64_tr_b16 v[144:145], v240 offset:12288
    ds_read_b64_tr_b16 v[146:147], v240 offset:13312
    ds_read_b64_tr_b16 v[148:149], v241 offset:12288
    ds_read_b64_tr_b16 v[150:151], v241 offset:13312
    ds_read_b64_tr_b16 v[152:153], v240 offset:14336
    ds_read_b64_tr_b16 v[154:155], v240 offset:15360
    ds_read_b64_tr_b16 v[156:157], v241 offset:14336
    ds_read_b64_tr_b16 v[158:159], v241 offset:15360
    v_xor_b32 v81, 32, v242
    v_xor_b32 v82, 64, v242
    v_xor_b32 v83, 96, v242
    v_xor_b32 v84, 128, v242
    v_xor_b32 v85, 160, v242
    v_xor_b32 v86, 192, v242
    v_xor_b32 v87, 224, v242
    v_xor_b32 v88, 16, v243
    s_add_u32 s51, s68, 262144
    s_add_u32 m0, s63, 98304
    s_and_b32 s51, s51, 0x7ffff
    buffer_load_dwordx4 v2, s[32:35], s51 offen lds
    buffer_load_dwordx4 v239, s[32:35], s51 offen offset:1024 lds
    s_add_u32 s51, s51, 65536
    s_add_u32 m0, s63, 106496
    s_and_b32 s51, s51, 0x7ffff
    buffer_load_dwordx4 v2, s[32:35], s51 offen lds
    buffer_load_dwordx4 v239, s[32:35], s51 offen offset:1024 lds
    s_add_u32 s51, s51, 65536
    s_add_u32 m0, s63, 114688
    s_and_b32 s51, s51, 0x7ffff
    buffer_load_dwordx4 v2, s[32:35], s51 offen lds
    buffer_load_dwordx4 v239, s[32:35], s51 offen offset:1024 lds
    s_add_u32 s51, s51, 65536
    s_add_u32 m0, s63, 122880
    s_and_b32 s51, s51, 0x7ffff
    buffer_load_dwordx4 v2, s[32:35], s51 offen lds
    buffer_load_dwordx4 v239, s[32:35], s51 offen offset:1024 lds
    s_waitcnt vmcnt(17) lgkmcnt(0)
    s_barrier
    s_cmp_lg_u32 s48, 0
    s_cbranch_scc1 L_skip_oa
    s_mov_b32 s69, 200000
L_rep_oa:
    global_load_dwordx2 v[90:91], v246, s[44:45] sc1
    buffer_load_dwordx2 v[92:93], v245, s[40:43], 0 offen sc1
    s_waitcnt vmcnt(0)
L_chk_oa:
    v_cmp_eq_u32 vcc, 0, v90
    v_mov_b32 v94, v92
    v_and_b32 v92, 0xffffffe1, v92
    v_cmp_ne_u64 s[46:47], v[90:91], v[92:93]
    s_nop 1
    s_or_b64 vcc, vcc, s[46:47]
    s_cbranch_scc0 L_nochk_oa
    s_sub_u32 s69, s69, 1
    s_cbranch_scc0 L_rep_oa
L_nochk_oa:
    v_or_b32 v92, s30, v90
    v_cmp_ne_u32 vcc, v92, v94
    s_nop 1
    s_cmp_eq_u64 vcc, 0
    s_cselect_b32 s51, 1, 0
    v_mov_b32 v92, s51
L_skip_oa:
    s_waitcnt lgkmcnt(0)
    s_barrier
    s_cmp_lg_u32 s48, 0
    s_cbranch_scc1 L_skip_same
    v_mov_b32 v93, 147456
    ds_write_b32 v93, v92
L_skip_same:
    s_add_u32 s52, s66, 4096
    s_add_u32 s53, s66, 32768
    s_add_u32 s54, s66, 36864
    buffer_load_dwordx4 v[16:19], v1, s[40:43], s66 offen sc1
    buffer_load_dwordx4 v[20:23], v1, s[40:43], s66 offen offset:1024 sc1
    buffer_load_dwordx4 v[24:27], v1, s[40:43], s66 offen offset:2048 sc1
    buffer_load_dwordx4 v[28:31], v1, s[40:43], s66 offen offset:3072 sc1
    buffer_load_dwordx4 v[32:35], v1, s[40:43], s52 offen sc1
    buffer_load_dwordx4 v[36:39], v1, s[40:43], s52 offen offset:1024 sc1
    buffer_load_dwordx4 v[40:43], v1, s[40:43], s52 offen offset:2048 sc1
    buffer_load_dwordx4 v[44:47], v1, s[40:43], s52 offen offset:3072 sc1
    buffer_load_dwordx4 v[48:51], v1, s[40:43], s53 offen sc1
    buffer_load_dwordx4 v[52:55], v1, s[40:43], s53 offen offset:1024 sc1
    buffer_load_dwordx4 v[56:59], v1, s[40:43], s53 offen offset:2048 sc1
    buffer_load_dwordx4 v[60:63], v1, s[40:43], s53 offen offset:3072 sc1
    buffer_load_dwordx4 v[64:67], v1, s[40:43], s54 offen sc1
    buffer_load_dwordx4 v[68:71], v1, s[40:43], s54 offen offset:1024 sc1
    buffer_load_dwordx4 v[72:75], v1, s[40:43], s54 offen offset:2048 sc1
    buffer_load_dwordx4 v[76:79], v1, s[40:43], s54 offen offset:3072 sc1
    s_waitcnt vmcnt(16) lgkmcnt(0)
    s_barrier
    s_setprio 0
    s_mov_b32 s69, 0
    s_mov_b32 s55, 0
    s_waitcnt vmcnt(0)
    v_mfma_f32_32x32x16_bf16 v[160:175], v[96:99], v[16:19], 0
    v_mfma_f32_32x32x16_bf16 v[176:191], v[100:103], v[16:19], 0
    v_mfma_f32_32x32x16_bf16 v[160:175], v[104:107], v[20:23], v[160:175]
    v_mfma_f32_32x32x16_bf16 v[176:191], v[108:111], v[20:23], v[176:191]
    v_mfma_f32_32x32x16_bf16 v[160:175], v[112:115], v[24:27], v[160:175]
    v_mfma_f32_32x32x16_bf16 v[176:191], v[116:119], v[24:27], v[176:191]
    v_mfma_f32_32x32x16_bf16 v[160:175], v[120:123], v[28:31], v[160:175]
    v_mfma_f32_32x32x16_bf16 v[176:191], v[124:127], v[28:31], v[176:191]
    v_mfma_f32_32x32x16_bf16 v[160:175], v[128:131], v[32:35], v[160:175]
    v_mfma_f32_32x32x16_bf16 v[176:191], v[132:135], v[32:35], v[176:191]
    v_mfma_f32_32x32x16_bf16 v[160:175], v[136:139], v[36:39], v[160:175]
    v_mfma_f32_32x32x16_bf16 v[176:191], v[140:143], v[36:39], v[176:191]
    v_mfma_f32_32x32x16_bf16 v[160:175], v[144:147], v[40:43], v[160:175]
    v_mfma_f32_32x32x16_bf16 v[176:191], v[148:151], v[40:43], v[176:191]
    v_mfma_f32_32x32x16_bf16 v[160:175], v[152:155], v[44:47], v[160:175]
    v_mfma_f32_32x32x16_bf16 v[176:191], v[156:159], v[44:47], v[176:191]
    v_mfma_f32_32x32x16_bf16 v[192:207], v[96:99], v[48:51], 0
    v_mfma_f32_32x32x16_bf16 v[208:223], v[100:103], v[48:51], 0
    v_mfma_f32_32x32x16_bf16 v[192:207], v[104:107], v[52:55], v[192:207]
    v_mfma_f32_32x32x16_bf16 v[208:223], v[108:111], v[52:55], v[208:223]
    v_mfma_f32_32x32x16_bf16 v[192:207], v[112:115], v[56:59], v[192:207]
    v_mfma_f32_32x32x16_bf16 v[208:223], v[116:119], v[56:59], v[208:223]
    v_mfma_f32_32x32x16_bf16 v[192:207], v[120:123], v[60:63], v[192:207]
    v_mfma_f32_32x32x16_bf16 v[208:223], v[124:127], v[60:63], v[208:223]
    v_mfma_f32_32x32x16_bf16 v[192:207], v[128:131], v[64:67], v[192:207]
    v_mfma_f32_32x32x16_bf16 v[208:223], v[132:135], v[64:67], v[208:223]
    v_mfma_f32_32x32x16_bf16 v[192:207], v[136:139], v[68:71], v[192:207]
    ds_write_b128 v242, v[160:163]
    ds_write_b128 v81, v[164:167]
    v_mfma_f32_32x32x16_bf16 v[208:223], v[140:143], v[68:71], v[208:223]
    ds_write_b128 v82, v[168:171]
    ds_write_b128 v83, v[172:175]
    v_mfma_f32_32x32x16_bf16 v[192:207], v[144:147], v[72:75], v[192:207]
    ds_write_b128 v84, v[176:179]
    ds_write_b128 v85, v[180:183]
    v_mfma_f32_32x32x16_bf16 v[208:223], v[148:151], v[72:75], v[208:223]
    ds_write_b128 v86, v[184:187]
    ds_write_b128 v87, v[188:191]
    v_mfma_f32_32x32x16_bf16 v[192:207], v[152:155], v[76:79], v[192:207]
    v_mfma_f32_32x32x16_bf16 v[208:223], v[156:159], v[76:79], v[208:223]
    s_nop 9
    s_branch L_tail_wr
L_fallback:
    s_cmp_eq_u32 s72, 0
    s_cbranch_scc1 L_fb_go
    s_cmp_eq_u32 s52, 1
    s_branch L_att_ok
L_fb_go:
    s_mov_b32 s72, 1
    v_mov_b32 v8, 0xff800000
    v_mov_b32 v10, 0xff800000
    s_mov_b32 s53, 0
L_fb_max:
    buffer_load_dwordx4 v[192:195], v1, s[40:43], s53 offen sc1
    s_waitcnt vmcnt(0)
    v_mfma_f32_32x32x16_bf16 v[96:111], v[192:195], v[208:211], 0
    v_mfma_f32_32x32x16_bf16 v[112:127], v[192:195], v[212:215], 0
    s_nop 15
    v_max3_f32 v8, v8, v96, v97
    v_max3_f32 v8, v8, v98, v99
    v_max3_f32 v8, v8, v100, v101
    v_max3_f32 v8, v8, v102, v103
    v_max3_f32 v8, v8, v104, v105
    v_max3_f32 v8, v8, v106, v107
    v_max3_f32 v8, v8, v108, v109
    v_max3_f32 v8, v8, v110, v111
    v_max3_f32 v10, v10, v112, v113
    v_max3_f32 v10, v10, v114, v115
    v_max3_f32 v10, v10, v116, v117
    v_max3_f32 v10, v10, v118, v119
    v_max3_f32 v10, v10, v120, v121
    v_max3_f32 v10, v10, v122, v123
    v_max3_f32 v10, v10, v124, v125
    v_max3_f32 v10, v10, v126, v127
    s_add_u32 s53, s53, 2048
    s_cmp_lt_u32 s53, 131072
    s_cbranch_scc1 L_fb_max
    v_mov_b32 v9, v8
    v_mov_b32 v11, v10
    s_nop 1
    v_permlane32_swap_b32 v8, v9
    v_permlane32_swap_b32 v10, v11
    v_max_f32 v8, v8, v9
    v_max_f32 v10, v10, v11
    v_sub_f32 v128, 0, v8
    v_sub_f32 v129, 0, v8
    v_sub_f32 v130, 0, v8
    v_sub_f32 v131, 0, v8
    v_sub_f32 v132, 0, v8
    v_sub_f32 v133, 0, v8
    v_sub_f32 v134, 0, v8
    v_sub_f32 v135, 0, v8
    v_sub_f32 v136, 0, v8
    v_sub_f32 v137, 0, v8
    v_sub_f32 v138, 0, v8
    v_sub_f32 v139, 0, v8
    v_sub_f32 v140, 0, v8
    v_sub_f32 v141, 0, v8
    v_sub_f32 v142, 0, v8
    v_sub_f32 v143, 0, v8
    v_sub_f32 v144, 0, v10
    v_sub_f32 v145, 0, v10
    v_sub_f32 v146, 0, v10
    v_sub_f32 v147, 0, v10
    v_sub_f32 v148, 0, v10
    v_sub_f32 v149, 0, v10
    v_sub_f32 v150, 0, v10
    v_sub_f32 v151, 0, v10
    v_sub_f32 v152, 0, v10
    v_sub_f32 v153, 0, v10
    v_sub_f32 v154, 0, v10
    v_sub_f32 v155, 0, v10
    v_sub_f32 v156, 0, v10
    v_sub_f32 v157, 0, v10
    v_sub_f32 v158, 0, v10
    v_sub_f32 v159, 0, v10
    v_mov_b32 v160, 0
    v_mov_b32 v161, 0
    v_mov_b32 v162, 0
    v_mov_b32 v163, 0
    v_mov_b32 v164, 0
    v_mov_b32 v165, 0
    v_mov_b32 v166, 0
    v_mov_b32 v167, 0
    v_mov_b32 v168, 0
    v_mov_b32 v169, 0
    v_mov_b32 v170, 0
    v_mov_b32 v171, 0
    v_mov_b32 v172, 0
    v_mov_b32 v173, 0
    v_mov_b32 v174, 0
    v_mov_b32 v175, 0
    v_mov_b32 v176, 0
    v_mov_b32 v177, 0
    v_mov_b32 v178, 0
    v_mov_b32 v179, 0
    v_mov_b32 v180, 0
    v_mov_b32 v181, 0
    v_mov_b32 v182, 0
    v_mov_b32 v183, 0
    v_mov_b32 v184, 0
    v_mov_b32 v185, 0
    v_mov_b32 v186, 0
    v_mov_b32 v187, 0
    v_mov_b32 v188, 0
    v_mov_b32 v189, 0
    v_mov_b32 v190, 0
    v_mov_b32 v191, 0
    v_lshlrev_b32 v10, 4, v7
    v_lshl_add_u32 v10, v6, 8, v10
    s_mov_b32 s53, 0
L_fb_pv:
    buffer_load_dwordx4 v[192:195], v1, s[40:43], s53 offen sc1
    s_mov_b64 exec, s[64:65]
    buffer_load_dwordx4 v[56:59], v10, s[40:43], s53 offen offset:1024 sc1
    buffer_load_dwordx4 v[60:63], v10, s[40:43], s53 offen offset:1536 sc1
    s_mov_b64 exec, -1
    s_waitcnt vmcnt(0)
    v_mfma_f32_32x32x16_bf16 v[96:111], v[192:195], v[208:211], v[128:143]
    v_mfma_f32_32x32x16_bf16 v[112:127], v[192:195], v[212:215], v[144:159]
    s_nop 15
    v_exp_f32 v96, v96
    v_exp_f32 v97, v97
    v_exp_f32 v98, v98
    v_exp_f32 v99, v99
    v_exp_f32 v100, v100
    v_exp_f32 v101, v101
    v_exp_f32 v102, v102
    v_exp_f32 v103, v103
    v_exp_f32 v104, v104
    v_exp_f32 v105, v105
    v_exp_f32 v106, v106
    v_exp_f32 v107, v107
    v_exp_f32 v108, v108
    v_exp_f32 v109, v109
    v_exp_f32 v110, v110
    v_exp_f32 v111, v111
    v_exp_f32 v112, v112
    v_exp_f32 v113, v113
    v_exp_f32 v114, v114
    v_exp_f32 v115, v115
    v_exp_f32 v116, v116
    v_exp_f32 v117, v117
    v_exp_f32 v118, v118
    v_exp_f32 v119, v119
    v_exp_f32 v120, v120
    v_exp_f32 v121, v121
    v_exp_f32 v122, v122
    v_exp_f32 v123, v123
    v_exp_f32 v124, v124
    v_exp_f32 v125, v125
    v_exp_f32 v126, v126
    v_exp_f32 v127, v127
    s_nop 1
    v_smfmac_f32_32x32x32_bf16 v[160:175], v[56:59], v[96:103], v236
    v_smfmac_f32_32x32x32_bf16 v[160:175], v[60:63], v[104:111], v236
    v_smfmac_f32_32x32x32_bf16 v[176:191], v[56:59], v[112:119], v236
    v_smfmac_f32_32x32x32_bf16 v[176:191], v[60:63], v[120:127], v236
    s_add_u32 s53, s53, 2048
    s_cmp_lt_u32 s53, 131072
    s_cbranch_scc1 L_fb_pv
    s_nop 15
    s_branch L_att_fin
L_tr0:
    s_sub_u32 s69, s69, 1
    s_cbranch_scc1 L_tk0
    buffer_load_dwordx4 v[16:19], v1, s[40:43], s66 offen sc1
    buffer_load_dwordx4 v[20:23], v1, s[40:43], s66 offen offset:1024 sc1
    buffer_load_dwordx4 v[24:27], v1, s[40:43], s66 offen offset:2048 sc1
    buffer_load_dwordx4 v[28:31], v1, s[40:43], s66 offen offset:3072 sc1
    s_waitcnt vmcnt(0)
    s_branch L_tg0
L_tr1:
    s_sub_u32 s69, s69, 1
    s_cbranch_scc1 L_tk1
    buffer_load_dwordx4 v[32:35], v1, s[40:43], s52 offen sc1
    buffer_load_dwordx4 v[36:39], v1, s[40:43], s52 offen offset:1024 sc1
    buffer_load_dwordx4 v[40:43], v1, s[40:43], s52 offen offset:2048 sc1
    buffer_load_dwordx4 v[44:47], v1, s[40:43], s52 offen offset:3072 sc1
    s_waitcnt vmcnt(0)
    s_branch L_tg1
L_tr2:
    s_sub_u32 s69, s69, 1
    s_cbranch_scc1 L_tk2
    buffer_load_dwordx4 v[48:51], v1, s[40:43], s53 offen sc1
    buffer_load_dwordx4 v[52:55], v1, s[40:43], s53 offen offset:1024 sc1
    buffer_load_dwordx4 v[56:59], v1, s[40:43], s53 offen offset:2048 sc1
    buffer_load_dwordx4 v[60:63], v1, s[40:43], s53 offen offset:3072 sc1
    s_waitcnt vmcnt(0)
    s_branch L_tg2
L_tr3:
    s_sub_u32 s69, s69, 1
    s_cbranch_scc1 L_tk3
    buffer_load_dwordx4 v[64:67], v1, s[40:43], s54 offen sc1
    buffer_load_dwordx4 v[68:71], v1, s[40:43], s54 offen offset:1024 sc1
    buffer_load_dwordx4 v[72:75], v1, s[40:43], s54 offen offset:2048 sc1
    buffer_load_dwordx4 v[76:79], v1, s[40:43], s54 offen offset:3072 sc1
    s_waitcnt vmcnt(0)
    s_branch L_tg3
L_st_slow:
    buffer_store_dwordx4 v[224:227], v1, s[40:43], s70 offen sc1
    buffer_store_dwordx4 v[228:231], v1, s[40:43], s70 offen offset:1024 sc1
    s_branch L_st_j
L_code_end:
.section .rodata,"a"
.p2align 6
.amdhsa_kernel concat_heads__sliding_local_dilated__grouped_kv_mqa__prompt_kernel
  .amdhsa_next_free_vgpr 256
  .amdhsa_next_free_sgpr 102
  .amdhsa_accum_offset 256
  .amdhsa_group_segment_fixed_size 0
  .amdhsa_kernarg_size 88
  .amdhsa_user_sgpr_count 2
  .amdhsa_user_sgpr_kernarg_segment_ptr 1
  .amdhsa_system_sgpr_workgroup_id_x 1
.end_amdhsa_kernel
```
